```python
import torch

def _softmax(x, axis=-1):
    return torch.softmax(x, dim=axis)
def _gelu(x):
    return torch.nn.functional.gelu(x, approximate="tanh")
def _silu(x):
    return torch.nn.functional.silu(x)
def _sigmoid(x):
    return torch.sigmoid(x)
def _layernorm(x, axis=-1, eps=1e-5):
    m = x.mean(dim=axis, keepdim=True)
    v = x.var(dim=axis, keepdim=True, unbiased=False)
    return (x - m) / torch.sqrt(v + eps)
def _scatter_add(tgt, idx, src, axis=0):
    return tgt.clone().index_add_(axis, idx, src)
def _segment_sum(src, seg, n):
    out = torch.zeros((n,) + src.shape[1:], dtype=src.dtype)
    return out.index_add_(0, seg, src)
def _pad(x, pw):
    flat = tuple(v for pair in reversed(pw) for v in pair)
    return torch.nn.functional.pad(x, flat)

kernel_name = 'recurrent_scan__spectral_gfnet__moe_arch_mod__prompt'

def setup_inputs():

    _w = (lambda a: (lambda t: t.to(torch.bfloat16) if t.is_floating_point() else t)(torch.as_tensor(a)))
    def _A_setup():
        B, S, D = 1, 2048, 1024
        Df = D // 2 + 1
        return {
            "x": _w((lambda *s: torch.randn(*s, dtype=torch.bfloat16) * 0.05)(B, S, D)),
            "w_r": _w((lambda *s: torch.randn(*s, dtype=torch.bfloat16) * 0.05)(S, Df) * 0.02),
            "w_i": _w((lambda *s: torch.randn(*s, dtype=torch.bfloat16) * 0.05)(S, Df) * 0.02),
        }
    _A_in = _A_setup()

    def _B_setup():
        B, S, D, F, C = 1, 2048, 1024, 3584, 1
        return {
            "x": _w((lambda *s: torch.randn(*s, dtype=torch.bfloat16) * 0.05)(B, S, D)),
            "w_r": _w((lambda *s: torch.randn(*s, dtype=torch.bfloat16) * 1.6)(D)),
            "w_gate": _w((lambda *s: torch.randn(*s, dtype=torch.bfloat16) * 0.1)(D, F)),
            "w_up": _w((lambda *s: torch.randn(*s, dtype=torch.bfloat16) * 0.1)(D, F)),
            "w_down": _w((lambda *s: torch.randn(*s, dtype=torch.bfloat16) * 0.1)(F, D)),
        }
    _B_in = _B_setup()

    return {
        "A_x": _A_in["x"],
        "A_w_r": _A_in["w_r"],
        "A_w_i": _A_in["w_i"],
        "B_x": _B_in["x"],
        "B_w_r": _B_in["w_r"],
        "B_w_gate": _B_in["w_gate"],
        "B_w_up": _B_in["w_up"],
        "B_w_down": _B_in["w_down"],
    }

def reference(A_x, A_w_r, A_w_i, B_x, B_w_r, B_w_gate, B_w_up, B_w_down):
    def _A_ref(x, w_r, w_i):
        B, S, D = x.shape
        X = (lambda x, axes=(-2,-1): torch.fft.rfft2(x.float(), dim=axes))(x, axes=(-2, -1))
        W = w_r + 1j * w_i
        X = X * W
        y = (lambda x, s, axes=(-2,-1): torch.fft.irfft2(x, s=s, dim=axes).to(torch.bfloat16))(X, (S, D), axes=(-2, -1))
        return y

    def _B_ref(x, w_r, w_gate, w_up, w_down):
        B, S, D = x.shape
        C = 1
        r = x @ w_r
        idx = torch.argsort(-r, axis=-1)[:, :C]
        idx_e = (lambda x, n, axis: torch.repeat_interleave(x, n, dim=axis))(idx.reshape(B, C, 1), D, axis=2)
        x_sel = (lambda x, i, axis: torch.take_along_dim(x, i, dim=axis))(x, idx_e, axis=1)
        g = _silu(x_sel @ w_gate)
        u = x_sel @ w_up
        y = (g * u) @ w_down
        r_sel = _sigmoid((lambda x, i, axis: torch.take_along_dim(x, i, dim=axis))(r, idx, axis=1))
        y = y * r_sel.reshape(B, C, 1)
        b_off = (torch.arange(B) * S).reshape(B, 1)
        flat_idx = (idx + b_off).reshape(B * C)
        zero = (x * 0.0).reshape(B * S, D)
        upd = _scatter_add(zero, flat_idx, y.reshape(B * C, D), axis=0)
        return x + upd.reshape(B, S, D)

    x = A_x
    xn = _layernorm(x, axis=-1)
    s = _A_ref(xn, A_w_r, A_w_i)
    g = _silu(_B_ref(xn, B_w_r, B_w_gate, B_w_up, B_w_down))
    return x + s * g
```

```asm
; @launch grid=(488,1,1) block=(512,1,1) lds=79872
.amdgcn_target "amdgcn-amd-amdhsa--gfx950"
.text
.globl recurrent_scan__spectral_gfnet__moe_arch_mod__prompt_kernel
.p2align 8
.type recurrent_scan__spectral_gfnet__moe_arch_mod__prompt_kernel,@function
recurrent_scan__spectral_gfnet__moe_arch_mod__prompt_kernel:
    s_cmp_ge_u32 s2, 488
    s_cbranch_scc1 recurrent_scan__spectral_gfnet__moe_arch_mod__prompt_kernel_end
    s_load_dwordx2 s[4:5], s[0:1], 0
    s_load_dwordx2 s[28:29], s[0:1], 32
    s_load_dwordx2 s[8:9], s[0:1], 80
    s_load_dwordx2 s[20:21], s[0:1], 8
    s_load_dwordx2 s[24:25], s[0:1], 16
    s_load_dwordx2 s[16:17], s[0:1], 64
    s_load_dwordx2 s[32:33], s[0:1], 40
    s_load_dwordx2 s[36:37], s[0:1], 48
    s_load_dwordx2 s[40:41], s[0:1], 56
    s_mov_b32 s6, 4194304
    s_mov_b32 s7, 0x00020000
    s_mov_b32 s30, 2048
    s_mov_b32 s31, 0x00020000
    s_mov_b32 s10, 16777216
    s_mov_b32 s11, 0x00020000
    s_mov_b32 s22, 2101248
    s_mov_b32 s23, 0x00020000
    s_mov_b32 s26, 2101248
    s_mov_b32 s27, 0x00020000
    s_mov_b32 s18, 4194304
    s_mov_b32 s19, 0x00020000
    s_mov_b32 s34, 7340032
    s_mov_b32 s35, 0x00020000
    s_mov_b32 s38, 7340032
    s_mov_b32 s39, 0x00020000
    s_mov_b32 s42, 7340032
    s_mov_b32 s43, 0x00020000
    s_getpc_b64 s[12:13]
recurrent_scan__spectral_gfnet__moe_arch_mod__prompt_kernel_pc:
    s_add_u32 s12, s12, fft_tables-recurrent_scan__spectral_gfnet__moe_arch_mod__prompt_kernel_pc
    s_addc_u32 s13, s13, 0
    s_mov_b32 s14, 39936
    s_mov_b32 s15, 0x00020000
    v_and_b32 v1, 63, v0
    v_lshrrev_b32 v6, 6, v0
    v_lshlrev_b32 v2, 4, v1
    v_readfirstlane_b32 s44, v6
    v_and_b32 v3, 0x30, v0
    v_lshlrev_b32 v3, 5, v3
    v_and_b32 v7, 15, v0
    v_lshl_add_u32 v4, v7, 2, v3
    v_lshl_add_u32 v3, v6, 19, v4
    s_lshl_b32 s51, s2, 11
    s_and_b32 s58, s2, 7
    s_lshr_b32 s59, s2, 3
    s_waitcnt lgkmcnt(0)
    s_cmp_ge_u32 s2, 256
    s_cbranch_scc1 L_second
    buffer_load_dword v16, v4, s[28:31], 0 offen offset:0
    buffer_load_dword v17, v4, s[28:31], 0 offen offset:64
    buffer_load_dword v18, v4, s[28:31], 0 offen offset:128
    buffer_load_dword v19, v4, s[28:31], 0 offen offset:192
    buffer_load_dword v20, v4, s[28:31], 0 offen offset:256
    buffer_load_dword v21, v4, s[28:31], 0 offen offset:320
    buffer_load_dword v22, v4, s[28:31], 0 offen offset:384
    buffer_load_dword v23, v4, s[28:31], 0 offen offset:448
    buffer_load_dword v8, v3, s[4:7], s51 offen offset:0
    buffer_load_dword v9, v3, s[4:7], s51 offen offset:64
    buffer_load_dword v10, v3, s[4:7], s51 offen offset:128
    buffer_load_dword v11, v3, s[4:7], s51 offen offset:192
    buffer_load_dword v12, v3, s[4:7], s51 offen offset:256
    buffer_load_dword v13, v3, s[4:7], s51 offen offset:320
    buffer_load_dword v14, v3, s[4:7], s51 offen offset:384
    buffer_load_dword v15, v3, s[4:7], s51 offen offset:448
    s_load_dword s68, s[8:9], 0
    s_barrier
    s_add_u32 s45, s44, 27
    s_lshl_b32 m0, s45, 10
    s_nop 0
    buffer_load_dwordx4 v2, s[12:15], m0 offen lds
    s_cmp_ge_u32 s44, 4
    s_cbranch_scc1 Ldt_27_1_72
    s_add_u32 s45, s44, 35
    s_lshl_b32 m0, s45, 10
    s_nop 0
    buffer_load_dwordx4 v2, s[12:15], m0 offen lds
Ldt_27_1_72:
    s_add_u32 s45, s44, 0
    s_lshl_b32 m0, s45, 10
    s_nop 0
    buffer_load_dwordx4 v2, s[12:15], m0 offen lds
    s_cmp_ge_u32 s44, 3
    s_cbranch_scc1 Ldt_0_1_83
    s_add_u32 s45, s44, 8
    s_lshl_b32 m0, s45, 10
    s_nop 0
    buffer_load_dwordx4 v2, s[12:15], m0 offen lds
Ldt_0_1_83:
    s_cmp_lt_u32 s44, 4
    s_cselect_b32 s32, s20, s24
    s_cselect_b32 s33, s21, s25
    s_mov_b32 s34, 2101248
    s_mov_b32 s35, 0x00020000
    s_mul_i32 s61, s58, 1026
    s_lshl_b32 s45, s59, 5
    s_add_u32 s61, s61, s45
    s_and_b32 s45, s58, 1
    s_lshl_b32 s60, s45, 4
    s_lshl_b32 s45, s45, 1
    s_sub_u32 s61, s61, s45
    s_and_b32 s46, s44, 3
    s_mul_i32 s45, s46, 525312
    s_add_u32 s61, s61, s45
    s_mul_i32 s46, s46, 5440
    s_lshr_b32 s45, s44, 2
    s_mul_i32 s45, s45, 40
    s_add_u32 s46, s46, s45
    s_add_u32 s46, s46, 46592
    v_mul_u32_u24 v6, 12, v1
    s_mov_b32 s47, 8172
    v_add_u32 v7, 0, v1
    v_mul_u32_u24 v7, 21846, v7
    v_lshrrev_b32 v7, 16, v7
    v_mad_u32_u24 v107, v7, 48, v6
    v_mad_u32_u24 v7, v7, s47, v6
    s_add_u32 s45, s61, 0
    buffer_load_dwordx3 v[104:106], v7, s[32:35], s45 offen
    s_add_u32 s45, s46, 0
    v_add_u32 v107, s45, v107
    v_add_u32 v7, 1, v1
    v_mul_u32_u24 v7, 21846, v7
    v_lshrrev_b32 v7, 16, v7
    v_mad_u32_u24 v111, v7, 48, v6
    v_mad_u32_u24 v7, v7, s47, v6
    s_add_u32 s45, s61, 172380
    buffer_load_dwordx3 v[108:110], v7, s[32:35], s45 offen
    s_add_u32 s45, s46, 1776
    v_add_u32 v111, s45, v111
    v_add_u32 v7, 2, v1
    v_mul_u32_u24 v7, 21846, v7
    v_lshrrev_b32 v7, 16, v7
    v_mad_u32_u24 v115, v7, 48, v6
    v_mad_u32_u24 v7, v7, s47, v6
    s_add_u32 s45, s61, 344760
    buffer_load_dwordx3 v[112:114], v7, s[32:35], s45 offen
    s_add_u32 s45, s46, 3552
    v_add_u32 v115, s45, v115
    s_lshl_b32 s52, s44, 8
    s_add_u32 s52, s52, s2
    v_bfe_u32 v51, v1, 1, 3
    v_and_b32 v53, 1, v1
    v_cmp_eq_u32 vcc, 1, v53
    v_lshrrev_b32 v52, 4, v1
    v_lshlrev_b32 v52, 1, v52
    v_add_u32 v53, 0, v52
    v_lshlrev_b32 v53, 8, v53
    v_add_u32 v53, s2, v53
    v_mul_lo_u32 v53, v53, v51
    v_and_b32 v53, 2047, v53
    v_cvt_f32_u32 v53, v53
    v_mul_f32 v53, 0x3a000000, v53
    v_cos_f32 v48, v53
    v_sin_f32 v49, v53
    s_nop 0
    v_sub_f32 v50, 0, v49
    v_cndmask_b32 v50, v48, v50, vcc
    v_cndmask_b32 v48, v49, v48, vcc
    v_cvt_pk_f16_f32 v116, v50, v48
    v_add_u32 v53, 1, v52
    v_lshlrev_b32 v53, 8, v53
    v_add_u32 v53, s2, v53
    v_mul_lo_u32 v53, v53, v51
    v_and_b32 v53, 2047, v53
    v_cvt_f32_u32 v53, v53
    v_mul_f32 v53, 0x3a000000, v53
    v_cos_f32 v48, v53
    v_sin_f32 v49, v53
    s_nop 0
    v_sub_f32 v50, 0, v49
    v_cndmask_b32 v50, v48, v50, vcc
    v_cndmask_b32 v48, v49, v48, vcc
    v_cvt_pk_f16_f32 v117, v50, v48
    v_and_b32 v6, 15, v1
    v_lshrrev_b32 v7, 4, v1
    v_mul_u32_u24 v118, 40, v6
    v_mul_u32_u24 v120, 2560, v7
    v_add_u32 v118, v118, v120
    s_lshl_b32 s46, s44, 2
    s_add_u32 s46, s46, 46592
    v_add_u32 v118, s46, v118
    v_add_u32 v119, 640, v118
    v_mul_u32_u24 v120, 160, v6
    v_lshl_add_u32 v120, v7, 3, v120
    s_mul_i32 s47, s44, 2560
    s_add_u32 s47, s47, 46592
    v_add_u32 v120, s47, v120
    s_mov_b32 s46, 1114112
    v_mul_lo_u32 v121, v7, s46
    v_lshrrev_b32 v7, 3, v6
    v_lshlrev_b32 v7, 15, v7
    v_and_b32 v6, 7, v6
    v_lshl_add_u32 v7, v6, 4, v7
    v_add_u32 v121, v121, v7
    s_lshl_b32 s65, s44, 16
    s_lshl_b32 s46, s2, 7
    s_add_u32 s65, s65, s46
    s_add_u32 s65, s65, 1048576
    s_add_u32 s66, s65, 557056
    s_add_u32 s67, s46, 1572864
    v_mov_b32 v123, 0xffff0000
    v_mov_b32 v122, 0x00010001
    s_waitcnt lgkmcnt(0)
    s_add_u32 s68, s68, 1
    s_and_b32 s69, s68, 0xff
    s_bfe_u32 s45, s69, 65536
    s_bfe_u32 s46, s69, 65537
    s_lshl_b32 s46, s46, 16
    s_or_b32 s70, s45, s46
    s_bfe_u32 s45, s69, 65538
    s_bfe_u32 s46, s69, 65539
    s_lshl_b32 s46, s46, 16
    s_or_b32 s71, s45, s46
    s_bfe_u32 s45, s69, 65540
    s_bfe_u32 s46, s69, 65541
    s_lshl_b32 s46, s46, 16
    s_or_b32 s72, s45, s46
    s_bfe_u32 s45, s69, 65542
    s_bfe_u32 s46, s69, 65543
    s_lshl_b32 s46, s46, 16
    s_or_b32 s73, s45, s46
    s_waitcnt vmcnt(13)
    s_mov_b32 s47, 0x3f803f80
    v_mov_b32 v48, 0
    v_dot2c_f32_bf16 v48, s47, v16
    v_dot2c_f32_bf16 v48, s47, v17
    v_dot2c_f32_bf16 v48, s47, v18
    v_dot2c_f32_bf16 v48, s47, v19
    v_dot2c_f32_bf16 v48, s47, v20
    v_dot2c_f32_bf16 v48, s47, v21
    v_dot2c_f32_bf16 v48, s47, v22
    v_dot2c_f32_bf16 v48, s47, v23
    s_nop 2
    v_add_f32_dpp v48, v48, v48 row_shr:1 row_mask:0xf bank_mask:0xf
    s_nop 1
    v_add_f32_dpp v48, v48, v48 row_shr:2 row_mask:0xf bank_mask:0xf
    s_nop 1
    v_add_f32_dpp v48, v48, v48 row_shr:4 row_mask:0xf bank_mask:0xf
    s_nop 1
    v_add_f32_dpp v48, v48, v48 row_shr:8 row_mask:0xf bank_mask:0xf
    s_nop 1
    v_add_f32_dpp v48, v48, v48 row_bcast:15 row_mask:0xa bank_mask:0xf
    s_nop 1
    v_add_f32_dpp v48, v48, v48 row_bcast:31 row_mask:0xc bank_mask:0xf
    s_nop 0
    v_readlane_b32 s57, v48, 63
    s_waitcnt vmcnt(3)
    s_barrier
    ds_read_b128 v[56:59], v2 offset:27648
    ds_read_b128 v[60:63], v2 offset:28672
    ds_read_b128 v[64:67], v2 offset:29696
    ds_read_b128 v[68:71], v2 offset:30720
    s_mov_b32 s47, 0x3f803f80
    s_mov_b32 s48, 0xbf803f80
    v_mov_b32 v48, 0
    v_mov_b32 v49, 0
    v_mov_b32 v50, 0
    v_mov_b32 v51, 0
    v_dot2c_f32_bf16 v48, s47, v8
    v_dot2c_f32_bf16 v49, v8, v8
    v_dot2c_f32_bf16 v50, v16, v8
    v_dot2c_f32_bf16 v51, s48, v8
    v_dot2c_f32_bf16 v48, s47, v9
    v_dot2c_f32_bf16 v49, v9, v9
    v_dot2c_f32_bf16 v50, v17, v9
    v_dot2c_f32_bf16 v51, s48, v9
    v_dot2c_f32_bf16 v48, s47, v10
    v_dot2c_f32_bf16 v49, v10, v10
    v_dot2c_f32_bf16 v50, v18, v10
    v_dot2c_f32_bf16 v51, s48, v10
    v_dot2c_f32_bf16 v48, s47, v11
    v_dot2c_f32_bf16 v49, v11, v11
    v_dot2c_f32_bf16 v50, v19, v11
    v_dot2c_f32_bf16 v51, s48, v11
    v_dot2c_f32_bf16 v48, s47, v12
    v_dot2c_f32_bf16 v49, v12, v12
    v_dot2c_f32_bf16 v50, v20, v12
    v_dot2c_f32_bf16 v51, s48, v12
    v_dot2c_f32_bf16 v48, s47, v13
    v_dot2c_f32_bf16 v49, v13, v13
    v_dot2c_f32_bf16 v50, v21, v13
    v_dot2c_f32_bf16 v51, s48, v13
    v_dot2c_f32_bf16 v48, s47, v14
    v_dot2c_f32_bf16 v49, v14, v14
    v_dot2c_f32_bf16 v50, v22, v14
    v_dot2c_f32_bf16 v51, s48, v14
    v_dot2c_f32_bf16 v48, s47, v15
    v_dot2c_f32_bf16 v49, v15, v15
    v_dot2c_f32_bf16 v50, v23, v15
    v_dot2c_f32_bf16 v51, s48, v15
    s_nop 1
    v_permlane32_swap_b32 v48, v50
    v_permlane32_swap_b32 v49, v51
    v_lshlrev_b32 v24, 16, v8
    v_add_f32 v48, v48, v50
    v_add_f32 v49, v49, v51
    v_and_b32 v32, v123, v8
    v_lshlrev_b32 v25, 16, v9
    v_permlane16_swap_b32 v48, v49
    v_and_b32 v33, v123, v9
    v_add_f32 v48, v48, v49
    v_lshlrev_b32 v26, 16, v10
    v_and_b32 v34, v123, v10
    v_add_f32_dpp v48, v48, v48 row_shr:1 row_mask:0xf bank_mask:0xf
    v_lshlrev_b32 v27, 16, v11
    v_and_b32 v35, v123, v11
    v_add_f32_dpp v48, v48, v48 row_shr:2 row_mask:0xf bank_mask:0xf
    v_lshlrev_b32 v28, 16, v12
    v_and_b32 v36, v123, v12
    v_add_f32_dpp v48, v48, v48 row_shr:4 row_mask:0xf bank_mask:0xf
    v_lshlrev_b32 v29, 16, v13
    v_and_b32 v37, v123, v13
    v_add_f32_dpp v48, v48, v48 row_shr:8 row_mask:0xf bank_mask:0xf
    v_lshlrev_b32 v30, 16, v14
    v_and_b32 v38, v123, v14
    v_lshlrev_b32 v31, 16, v15
    v_and_b32 v39, v123, v15
    v_readlane_b32 s45, v48, 15
    v_readlane_b32 s46, v48, 31
    v_readlane_b32 s47, v48, 47
    v_readlane_b32 s48, v48, 63
    v_mov_b32 v52, s45
    v_mov_b32 v54, s46
    v_mul_f32 v52, 0x3a800000, v52
    v_mul_f32 v54, 0x3a800000, v54
    v_cvt_pk_bf16_f32 v53, v52, v52
    v_fma_f32 v54, -v52, v52, v54
    v_and_b32 v53, v123, v53
    v_max_f32 v54, 0, v54
    v_cvt_pk_bf16_f32 v54, v54, v54
    v_mov_b32 v52, s57
    v_and_b32 v54, v123, v54
    v_mul_f32 v52, v53, v52
    v_add_f32 v54, 0x3727c5ac, v54
    v_sub_f32 v52, s47, v52
    v_cvt_pk_bf16_f32 v54, v54, v54
    v_mov_b32 v55, s48
    v_and_b32 v54, v123, v54
    v_sqrt_f32 v54, v54
    v_readfirstlane_b32 s54, v53
    v_cvt_pk_bf16_f32 v54, v54, v54
    v_and_b32 v54, v123, v54
    v_rcp_f32 v54, v54
    s_nop 0
    v_mul_f32 v53, v53, v54
    v_mul_f32 v52, v52, v54
    v_sub_f32 v53, 0, v53
    v_mul_f32 v55, v55, v54
    v_fma_f32 v24, v24, v54, v53
    v_fma_f32 v25, v25, v54, v53
    v_fma_f32 v26, v26, v54, v53
    v_fma_f32 v27, v27, v54, v53
    v_fma_f32 v28, v28, v54, v53
    v_fma_f32 v29, v29, v54, v53
    v_fma_f32 v30, v30, v54, v53
    v_fma_f32 v31, v31, v54, v53
    v_fma_f32 v32, v32, v54, v53
    v_fma_f32 v33, v33, v54, v53
    v_fma_f32 v34, v34, v54, v53
    v_fma_f32 v35, v35, v54, v53
    v_fma_f32 v36, v36, v54, v53
    v_fma_f32 v37, v37, v54, v53
    v_fma_f32 v38, v38, v54, v53
    v_fma_f32 v39, v39, v54, v53
    v_cvt_pk_bf16_f32 v40, v24, v25
    v_cvt_pk_bf16_f32 v41, v26, v27
    v_cvt_pk_bf16_f32 v42, v28, v29
    v_cvt_pk_bf16_f32 v43, v30, v31
    v_cvt_pk_bf16_f32 v44, v32, v33
    v_cvt_pk_bf16_f32 v45, v34, v35
    v_cvt_pk_bf16_f32 v46, v36, v37
    v_cvt_pk_bf16_f32 v47, v38, v39
    ds_read_b128 v[8:11], v2 offset:31744
    ds_read_b128 v[12:15], v2 offset:32768
    ds_read_b128 v[16:19], v2 offset:33792
    ds_read_b128 v[20:23], v2 offset:34816
    s_waitcnt lgkmcnt(4)
    v_mfma_f32_16x16x32_bf16 v[72:75], v[40:43], v[56:59], 0
    v_mfma_f32_16x16x32_bf16 v[76:79], v[40:43], v[60:63], 0
    v_mfma_f32_16x16x32_bf16 v[80:83], v[44:47], v[56:59], 0
    v_mfma_f32_16x16x32_bf16 v[84:87], v[44:47], v[60:63], 0
    v_mfma_f32_16x16x32_bf16 v[88:91], v[40:43], v[64:67], 0
    v_mfma_f32_16x16x32_bf16 v[92:95], v[40:43], v[68:71], 0
    v_mfma_f32_16x16x32_bf16 v[96:99], v[44:47], v[64:67], 0
    v_mfma_f32_16x16x32_bf16 v[100:103], v[44:47], v[68:71], 0
    ds_read_b128 v[24:27], v2 offset:35840
    ds_read_b128 v[28:31], v2 offset:36864
    ds_read_b128 v[32:35], v2 offset:37888
    ds_read_b128 v[36:39], v2 offset:38912
    v_cvt_pk_bf16_f32 v52, v52, v52
    v_mul_f32 v55, 0.25, v55
    v_readfirstlane_b32 s55, v54
    v_readfirstlane_b32 s56, v53
    v_readfirstlane_b32 s46, v52
    v_cvt_pk_f16_f32 v55, v55, 0
    s_and_b32 s46, s46, 0xffff
    s_or_b32 s47, s46, 0x8000
    s_xor_b32 s50, s46, 0xffff
    s_bitcmp1_b32 s46, 15
    s_cselect_b32 s46, s50, s47
    s_lshl_b32 s46, s46, 16
    s_sub_u32 s47, 2047, s52
    s_or_b32 s53, s46, s47
    s_lshl_b32 s47, s44, 4
    s_add_u32 s47, s47, 68352
    s_lshl_b32 s46, s44, 2
    s_add_u32 s46, s46, 67072
    s_mov_b64 exec, 1
    v_mov_b32 v6, s47
    v_mov_b32 v48, s53
    v_mov_b32 v49, s54
    v_mov_b32 v50, s55
    ds_write_b128 v6, v[48:51]
    v_mov_b32 v7, s46
    ds_write_b32 v7, v55
    s_mov_b64 exec, -1
    s_waitcnt lgkmcnt(0)
    s_barrier
    s_cmp_lg_u32 s44, 7
    s_cbranch_scc1 Lcand_411
    v_and_b32 v6, 7, v1
    v_lshlrev_b32 v6, 4, v6
    v_add_u32 v6, 68352, v6
    ds_read_b128 v[48:51], v6
    s_waitcnt lgkmcnt(0)
    v_mov_b32 v52, v48
    s_nop 1
    v_max_u32_dpp v52, v52, v52 row_shr:1 row_mask:0xf bank_mask:0xf
    s_nop 1
    v_max_u32_dpp v52, v52, v52 row_shr:2 row_mask:0xf bank_mask:0xf
    s_nop 1
    v_max_u32_dpp v52, v52, v52 row_shr:4 row_mask:0xf bank_mask:0xf
    s_nop 0
    v_readlane_b32 s46, v52, 7
    s_nop 1
    v_cmp_eq_u32 vcc, s46, v48
    s_ff1_i32_b64 s47, vcc
    v_readlane_b32 s50, v49, s47
    v_readlane_b32 s45, v50, s47
    v_mov_b32 v48, s46
    v_mov_b32 v49, s50
    v_mov_b32 v50, s45
    v_mov_b32 v51, s68
    v_lshlrev_b32 v6, 12, v1
    s_lshl_b32 s46, s2, 4
    s_add_u32 s46, s46, 131072
    s_mov_b32 exec_lo, 0x3
    s_mov_b32 exec_hi, 0
    buffer_store_dwordx4 v[48:51], v6, s[8:11], s46 offen sc0 sc1
    s_mov_b64 exec, -1
Lcand_411:
    v_cvt_pk_f16_f32 v56, v72, v76
    v_cvt_pk_f16_f32 v57, v73, v77
    v_cvt_pk_f16_f32 v58, v74, v78
    v_cvt_pk_f16_f32 v59, v75, v79
    v_cvt_pk_f16_f32 v60, v80, v84
    v_cvt_pk_f16_f32 v61, v81, v85
    v_cvt_pk_f16_f32 v62, v82, v86
    v_cvt_pk_f16_f32 v63, v83, v87
    v_pk_mul_f16 v72, v56, v8 op_sel:[0,0] op_sel_hi:[0,1]
    v_pk_mul_f16 v73, v57, v9 op_sel:[0,0] op_sel_hi:[0,1]
    v_pk_mul_f16 v74, v58, v10 op_sel:[0,0] op_sel_hi:[0,1]
    v_pk_mul_f16 v75, v59, v11 op_sel:[0,0] op_sel_hi:[0,1]
    v_pk_mul_f16 v80, v60, v12 op_sel:[0,0] op_sel_hi:[0,1]
    v_pk_mul_f16 v81, v61, v13 op_sel:[0,0] op_sel_hi:[0,1]
    v_pk_mul_f16 v82, v62, v14 op_sel:[0,0] op_sel_hi:[0,1]
    v_pk_mul_f16 v83, v63, v15 op_sel:[0,0] op_sel_hi:[0,1]
    v_pk_fma_f16 v56, v56, v8, v72 op_sel:[1,1,0] op_sel_hi:[1,0,1] neg_lo:[0,1,0]
    v_pk_fma_f16 v57, v57, v9, v73 op_sel:[1,1,0] op_sel_hi:[1,0,1] neg_lo:[0,1,0]
    v_pk_fma_f16 v58, v58, v10, v74 op_sel:[1,1,0] op_sel_hi:[1,0,1] neg_lo:[0,1,0]
    v_pk_fma_f16 v59, v59, v11, v75 op_sel:[1,1,0] op_sel_hi:[1,0,1] neg_lo:[0,1,0]
    v_pk_fma_f16 v60, v60, v12, v80 op_sel:[1,1,0] op_sel_hi:[1,0,1] neg_lo:[0,1,0]
    v_pk_fma_f16 v61, v61, v13, v81 op_sel:[1,1,0] op_sel_hi:[1,0,1] neg_lo:[0,1,0]
    v_pk_fma_f16 v62, v62, v14, v82 op_sel:[1,1,0] op_sel_hi:[1,0,1] neg_lo:[0,1,0]
    v_pk_fma_f16 v63, v63, v15, v83 op_sel:[1,1,0] op_sel_hi:[1,0,1] neg_lo:[0,1,0]
    v_mfma_f32_16x16x32_f16 v[72:75], v[24:27], v[56:59], 0
    v_mfma_f32_16x16x32_f16 v[76:79], v[28:31], v[56:59], 0
    v_mfma_f32_16x16x32_f16 v[72:75], v[32:35], v[60:63], v[72:75]
    v_mfma_f32_16x16x32_f16 v[76:79], v[36:39], v[60:63], v[76:79]
    v_cvt_pk_f16_f32 v64, v88, v92
    v_cvt_pk_f16_f32 v65, v89, v93
    v_cvt_pk_f16_f32 v66, v90, v94
    v_cvt_pk_f16_f32 v67, v91, v95
    v_cvt_pk_f16_f32 v68, v96, v100
    v_cvt_pk_f16_f32 v69, v97, v101
    v_cvt_pk_f16_f32 v70, v98, v102
    v_cvt_pk_f16_f32 v71, v99, v103
    v_pk_mul_f16 v88, v64, v16 op_sel:[0,0] op_sel_hi:[0,1]
    v_pk_mul_f16 v89, v65, v17 op_sel:[0,0] op_sel_hi:[0,1]
    v_pk_mul_f16 v90, v66, v18 op_sel:[0,0] op_sel_hi:[0,1]
    v_pk_mul_f16 v91, v67, v19 op_sel:[0,0] op_sel_hi:[0,1]
    v_pk_mul_f16 v96, v68, v20 op_sel:[0,0] op_sel_hi:[0,1]
    v_pk_mul_f16 v97, v69, v21 op_sel:[0,0] op_sel_hi:[0,1]
    v_pk_mul_f16 v98, v70, v22 op_sel:[0,0] op_sel_hi:[0,1]
    v_pk_mul_f16 v99, v71, v23 op_sel:[0,0] op_sel_hi:[0,1]
    v_pk_fma_f16 v64, v64, v16, v88 op_sel:[1,1,0] op_sel_hi:[1,0,1] neg_lo:[0,1,0]
    v_pk_fma_f16 v65, v65, v17, v89 op_sel:[1,1,0] op_sel_hi:[1,0,1] neg_lo:[0,1,0]
    v_pk_fma_f16 v66, v66, v18, v90 op_sel:[1,1,0] op_sel_hi:[1,0,1] neg_lo:[0,1,0]
    v_pk_fma_f16 v67, v67, v19, v91 op_sel:[1,1,0] op_sel_hi:[1,0,1] neg_lo:[0,1,0]
    v_pk_fma_f16 v68, v68, v20, v96 op_sel:[1,1,0] op_sel_hi:[1,0,1] neg_lo:[0,1,0]
    v_pk_fma_f16 v69, v69, v21, v97 op_sel:[1,1,0] op_sel_hi:[1,0,1] neg_lo:[0,1,0]
    v_pk_fma_f16 v70, v70, v22, v98 op_sel:[1,1,0] op_sel_hi:[1,0,1] neg_lo:[0,1,0]
    v_pk_fma_f16 v71, v71, v23, v99 op_sel:[1,1,0] op_sel_hi:[1,0,1] neg_lo:[0,1,0]
    v_mfma_f32_16x16x32_f16 v[80:83], v[24:27], v[64:67], 0
    v_mfma_f32_16x16x32_f16 v[84:87], v[28:31], v[64:67], 0
    v_mfma_f32_16x16x32_f16 v[80:83], v[32:35], v[68:71], v[80:83]
    v_mfma_f32_16x16x32_f16 v[84:87], v[36:39], v[68:71], v[84:87]
    v_cvt_pk_f16_f32 v40, v72, v73
    v_cvt_pk_f16_f32 v41, v74, v75
    ds_write2st64_b32 v118, v40, v41 offset0:0 offset1:5
    v_cvt_pk_f16_f32 v42, v76, v77
    v_cvt_pk_f16_f32 v43, v78, v79
    ds_write2st64_b32 v118, v42, v43 offset0:40 offset1:45
    s_nop 0
    v_cvt_pk_f16_f32 v44, v80, v81
    v_cvt_pk_f16_f32 v45, v82, v83
    ds_write2st64_b32 v119, v44, v45 offset0:0 offset1:5
    v_cvt_pk_f16_f32 v46, v84, v85
    v_cvt_pk_f16_f32 v47, v86, v87
    ds_write2st64_b32 v119, v46, v47 offset0:40 offset1:45
    s_waitcnt lgkmcnt(0)
    s_barrier
    ds_read2_b64 v[8:11], v120 offset0:0 offset1:5
    ds_read2_b64 v[12:15], v120 offset0:10 offset1:15
    s_waitcnt lgkmcnt(1)
    v_mfma_f32_16x16x16_f16 v[16:19], v[116:117], v[8:9], 0
    v_mfma_f32_16x16x16_f16 v[20:23], v[116:117], v[10:11], 0
    s_waitcnt lgkmcnt(0)
    v_mfma_f32_16x16x16_f16 v[24:27], v[116:117], v[12:13], 0
    v_mfma_f32_16x16x16_f16 v[28:31], v[116:117], v[14:15], 0
    s_nop 3
    v_cvt_pk_f16_f32 v32, v16, v17
    v_cvt_pk_f16_f32 v33, v20, v21
    s_nop 0
    v_cvt_pk_f16_f32 v34, v24, v25
    v_cvt_pk_f16_f32 v35, v28, v29
    v_bfi_b32 v32, v122, s70, v32
    v_bfi_b32 v33, v122, s71, v33
    v_bfi_b32 v34, v122, s72, v34
    v_bfi_b32 v35, v122, s73, v35
    buffer_store_dwordx4 v[32:35], v121, s[8:11], s65 offen sc0 sc1
    v_cvt_pk_f16_f32 v36, v18, v19
    v_cvt_pk_f16_f32 v37, v22, v23
    v_cvt_pk_f16_f32 v38, v26, v27
    v_cvt_pk_f16_f32 v39, v30, v31
    v_bfi_b32 v36, v122, s70, v36
    v_bfi_b32 v37, v122, s71, v37
    v_bfi_b32 v38, v122, s72, v38
    v_bfi_b32 v39, v122, s73, v39
    buffer_store_dwordx4 v[36:39], v121, s[8:11], s66 offen sc0 sc1
    s_cmp_lg_u32 s44, 7
    s_cbranch_scc1 Lnyq_535
    v_lshrrev_b32 v40, 4, v1
    v_lshlrev_b32 v40, 3, v40
    v_add_u32 v40, 46592, v40
    ds_read_b64 v[8:9], v40 offset:20480
    s_waitcnt lgkmcnt(0)
    v_mfma_f32_16x16x16_f16 v[16:19], v[116:117], v[8:9], 0
    v_and_b32 v42, 8, v1
    v_cmp_ne_u32 vcc, 0, v42
    s_nop 5
    v_cndmask_b32 v16, v16, v18, vcc
    v_cndmask_b32 v17, v17, v19, vcc
    v_cvt_pk_f16_f32 v20, v16, v17
    v_mov_b32 v21, s68
    v_lshrrev_b32 v43, 3, v1
    v_lshlrev_b32 v43, 11, v43
    s_lshl_b32 s46, s2, 3
    s_add_u32 s46, s46, 65536
    s_mov_b32 exec_lo, 0x01010101
    s_mov_b32 exec_hi, 0x01010101
    buffer_store_dwordx2 v[20:21], v43, s[8:11], s46 offen sc0 sc1
    s_mov_b64 exec, -1
Lnyq_535:
L_window1:
    s_add_u32 s45, s44, 11
    s_lshl_b32 m0, s45, 10
    s_nop 0
    buffer_load_dwordx4 v2, s[12:15], m0 offen lds
    s_add_u32 s45, s44, 19
    s_lshl_b32 m0, s45, 10
    s_nop 0
    buffer_load_dwordx4 v2, s[12:15], m0 offen lds
    s_xor_b32 s47, s69, 0xfe
    s_bfe_u32 s45, s47, 65536
    s_bfe_u32 s46, s47, 65537
    s_lshl_b32 s46, s46, 16
    s_or_b32 s28, s45, s46
    s_bfe_u32 s45, s47, 65538
    s_bfe_u32 s46, s47, 65539
    s_lshl_b32 s46, s46, 16
    s_or_b32 s29, s45, s46
    s_bfe_u32 s45, s47, 65540
    s_bfe_u32 s46, s47, 65541
    s_lshl_b32 s46, s46, 16
    s_or_b32 s30, s45, s46
    s_bfe_u32 s45, s47, 65542
    s_bfe_u32 s46, s47, 65543
    s_lshl_b32 s46, s46, 16
    s_or_b32 s31, s45, s46
    s_cmp_eq_u32 s44, 7
    s_cbranch_scc1 L_w1w7
    s_waitcnt vmcnt(4)
    s_branch L_w1go
L_w1w7:
    s_waitcnt vmcnt(5)
L_w1go:
    s_barrier
    ds_write_b32 v107, v104 offset:0
    ds_write_b32 v107, v105 offset:4
    ds_write_b32 v107, v106 offset:8
    ds_write_b32 v111, v108 offset:0
    ds_write_b32 v111, v109 offset:4
    ds_write_b32 v111, v110 offset:8
    ds_write_b32 v115, v112 offset:0
    ds_write_b32 v115, v113 offset:4
    ds_write_b32 v115, v114 offset:8
    v_and_b32 v6, 15, v1
    v_lshrrev_b32 v7, 4, v1
    v_mul_u32_u24 v5, 80, v6
    v_mul_u32_u24 v3, 5120, v7
    v_add_u32 v5, v5, v3
    s_lshl_b32 s45, s44, 3
    s_add_u32 s45, s45, 46592
    v_add_u32 v100, s45, v5
    v_mul_u32_u24 v5, 84, v6
    v_mul_u32_u24 v3, 5440, v7
    v_add_u32 v5, v5, v3
    s_lshl_b32 s45, s44, 2
    s_add_u32 s46, s45, 46592
    v_add_u32 v3, s46, v5
    v_add_u32 v4, 1344, v3
    v_add_u32 v5, 2688, v3
    v_add_u32 v6, 4032, v3
    s_waitcnt lgkmcnt(0)
    s_barrier
    ds_read2_b32 v[84:85], v3 offset0:0 offset1:1
    ds_read2_b32 v[86:87], v3 offset0:10 offset1:11
    ds_read2_b32 v[88:89], v4 offset0:0 offset1:1
    ds_read2_b32 v[90:91], v4 offset0:10 offset1:11
    ds_read2_b32 v[92:93], v5 offset0:0 offset1:1
    ds_read2_b32 v[94:95], v5 offset0:10 offset1:11
    ds_read2_b32 v[96:97], v6 offset0:0 offset1:1
    ds_read2_b32 v[98:99], v6 offset0:10 offset1:11
    ds_read_b128 v[8:11], v2 offset:0
    ds_read_b128 v[12:15], v2 offset:1024
    ds_read_b128 v[16:19], v2 offset:2048
    ds_read_b128 v[20:23], v2 offset:3072
    ds_read_b128 v[24:27], v2 offset:4096
    ds_read_b128 v[28:31], v2 offset:5120
    ds_read_b128 v[32:35], v2 offset:6144
    s_waitcnt lgkmcnt(7)
    v_alignbit_b32 v84, v85, v84, s60
    v_alignbit_b32 v86, v87, v86, s60
    v_lshlrev_b32 v52, 16, v84
    v_lshlrev_b32 v53, 16, v86
    v_and_b32 v54, 0xffff0000, v84
    v_and_b32 v55, 0xffff0000, v86
    v_alignbit_b32 v88, v89, v88, s60
    v_alignbit_b32 v90, v91, v90, s60
    v_lshlrev_b32 v56, 16, v88
    v_lshlrev_b32 v57, 16, v90
    v_and_b32 v58, 0xffff0000, v88
    v_and_b32 v59, 0xffff0000, v90
    v_alignbit_b32 v92, v93, v92, s60
    v_alignbit_b32 v94, v95, v94, s60
    v_lshlrev_b32 v60, 16, v92
    v_lshlrev_b32 v61, 16, v94
    v_and_b32 v62, 0xffff0000, v92
    v_and_b32 v63, 0xffff0000, v94
    v_alignbit_b32 v96, v97, v96, s60
    v_alignbit_b32 v98, v99, v98, s60
    v_lshlrev_b32 v64, 16, v96
    v_lshlrev_b32 v65, 16, v98
    v_and_b32 v66, 0xffff0000, v96
    v_and_b32 v67, 0xffff0000, v98
    ds_read_b128 v[36:39], v2 offset:7168
    ds_read_b128 v[40:43], v2 offset:8192
    ds_read_b128 v[44:47], v2 offset:9216
    ds_read_b128 v[48:51], v2 offset:10240
    v_mov_b32 v6, v100
    s_mul_i32 s62, s58, 557056
    s_lshr_b32 s45, s59, 1
    s_lshl_b32 s45, s45, 15
    s_add_u32 s62, s62, s45
    s_and_b32 s45, s59, 1
    s_lshl_b32 s45, s45, 6
    s_add_u32 s62, s62, s45
    s_lshl_b32 s45, s44, 12
    s_add_u32 s62, s62, s45
    s_add_u32 s62, s62, 1048576
    v_lshrrev_b32 v7, 2, v1
    v_and_b32 v5, 3, v1
    v_lshlrev_b32 v3, 7, v7
    v_lshl_add_u32 v3, v5, 4, v3
    v_lshlrev_b32 v4, 4, v7
    v_mul_u32_u24 v108, 4128, v5
    v_add_u32 v4, v4, v108
    s_lshl_b32 s45, s44, 9
    s_add_u32 s45, s45, 27648
    v_add_u32 v4, s45, v4
    v_mul_u32_u24 v7, 80, v7
    v_lshl_add_u32 v7, v5, 4, v7
    s_mul_i32 s45, s44, 2560
    s_add_u32 s45, s45, 46592
    v_add_u32 v7, s45, v7
    v_lshrrev_b32 v5, 4, v1
    v_lshlrev_b32 v5, 10, v5
    v_and_b32 v108, 15, v1
    v_lshl_add_u32 v5, v108, 4, v5
    s_lshr_b32 s45, s44, 1
    s_mul_i32 s45, s45, 4128
    s_and_b32 s46, s44, 1
    s_lshl_b32 s46, s46, 3
    s_add_u32 s45, s45, s46
    s_add_u32 s45, s45, 27648
    v_add_u32 v5, s45, v5
    v_mov_b32 v115, 0x00010001
    s_mov_b32 s75, 0
    s_waitcnt lgkmcnt(0)
    s_waitcnt vmcnt(0)
L_pollA:
    buffer_load_dwordx4 v[116:119], v3, s[8:11], s62 offen sc0 sc1
    buffer_load_dwordx4 v[120:123], v3, s[8:11], s62 offen offset:2048 sc0 sc1
    s_waitcnt vmcnt(0)
    v_xor_b32 v116, s70, v116
    v_xor_b32 v117, s71, v117
    v_xor_b32 v118, s72, v118
    v_xor_b32 v119, s73, v119
    v_xor_b32 v120, s70, v120
    v_xor_b32 v121, s71, v121
    v_xor_b32 v122, s72, v122
    v_xor_b32 v123, s73, v123
    v_or_b32 v84, v116, v117
    v_or_b32 v85, v118, v119
    v_or_b32 v86, v120, v121
    v_or_b32 v87, v122, v123
    v_or_b32 v84, v84, v85
    v_or_b32 v86, v86, v87
    v_or_b32 v84, v84, v86
    v_and_b32 v84, v115, v84
    v_cmp_ne_u32 vcc, 0, v84
    s_nop 4
    s_cbranch_vccz L_pollA_done
    s_add_u32 s75, s75, 1
    s_cmp_gt_u32 s75, 20000
    s_cbranch_scc1 L_pollA_done
    s_sleep 4
    s_branch L_pollA
L_pollA_done:
    ds_write_b128 v4, v[116:119]
    ds_write_b128 v4, v[120:123] offset:256
    s_waitcnt lgkmcnt(0)
    s_barrier
    ds_read2_b64 v[68:71], v5 offset0:0 offset1:32
    ds_read2_b64 v[72:75], v5 offset0:64 offset1:96
    s_waitcnt lgkmcnt(0)
    v_mov_b32 v76, v69
    v_mov_b32 v77, v71
    v_mov_b32 v78, v73
    v_mov_b32 v79, v75
    v_mov_b32 v69, v70
    v_mov_b32 v70, v72
    v_mov_b32 v71, v74
    v_mfma_f32_16x16x32_f16 v[92:95], v[76:79], v[8:11], 0
    v_mfma_f32_16x16x32_f16 v[96:99], v[76:79], v[12:15], 0
    v_mfma_f32_16x16x32_f16 v[84:87], v[68:71], v[8:11], 0
    v_mfma_f32_16x16x32_f16 v[88:91], v[68:71], v[12:15], 0
    s_nop 5
    v_cvt_pk_f16_f32 v104, v92, v96
    v_cvt_pk_f16_f32 v105, v93, v97
    v_cvt_pk_f16_f32 v106, v94, v98
    v_cvt_pk_f16_f32 v107, v95, v99
    v_pk_mul_f16 v92, v104, v16 op_sel:[0,0] op_sel_hi:[0,1]
    v_pk_mul_f16 v93, v105, v17 op_sel:[0,0] op_sel_hi:[0,1]
    v_pk_mul_f16 v94, v106, v18 op_sel:[0,0] op_sel_hi:[0,1]
    v_pk_mul_f16 v95, v107, v19 op_sel:[0,0] op_sel_hi:[0,1]
    v_pk_fma_f16 v104, v104, v16, v92 op_sel:[1,1,0] op_sel_hi:[1,0,1] neg_lo:[0,1,0]
    v_pk_fma_f16 v105, v105, v17, v93 op_sel:[1,1,0] op_sel_hi:[1,0,1] neg_lo:[0,1,0]
    v_pk_fma_f16 v106, v106, v18, v94 op_sel:[1,1,0] op_sel_hi:[1,0,1] neg_lo:[0,1,0]
    v_pk_fma_f16 v107, v107, v19, v95 op_sel:[1,1,0] op_sel_hi:[1,0,1] neg_lo:[0,1,0]
    s_nop 1
    v_mfma_f32_16x16x32_f16 v[92:95], v[20:23], v[104:107], 0
    v_mfma_f32_16x16x32_f16 v[96:99], v[24:27], v[104:107], 0
    v_cvt_pk_f16_f32 v100, v84, v88
    v_cvt_pk_f16_f32 v101, v85, v89
    v_cvt_pk_f16_f32 v102, v86, v90
    v_cvt_pk_f16_f32 v103, v87, v91
    v_pk_mul_f16 v84, v100, v16 op_sel:[0,0] op_sel_hi:[0,1]
    v_pk_mul_f16 v85, v101, v17 op_sel:[0,0] op_sel_hi:[0,1]
    v_pk_mul_f16 v86, v102, v18 op_sel:[0,0] op_sel_hi:[0,1]
    v_pk_mul_f16 v87, v103, v19 op_sel:[0,0] op_sel_hi:[0,1]
    v_pk_fma_f16 v100, v100, v16, v84 op_sel:[1,1,0] op_sel_hi:[1,0,1] neg_lo:[0,1,0]
    v_pk_fma_f16 v101, v101, v17, v85 op_sel:[1,1,0] op_sel_hi:[1,0,1] neg_lo:[0,1,0]
    v_pk_fma_f16 v102, v102, v18, v86 op_sel:[1,1,0] op_sel_hi:[1,0,1] neg_lo:[0,1,0]
    v_pk_fma_f16 v103, v103, v19, v87 op_sel:[1,1,0] op_sel_hi:[1,0,1] neg_lo:[0,1,0]
    s_nop 1
    v_mfma_f32_16x16x32_f16 v[84:87], v[20:23], v[100:103], 0
    v_mfma_f32_16x16x32_f16 v[88:91], v[24:27], v[100:103], 0
    v_mul_f32 v108, v92, v54
    v_mul_f32 v109, v92, v55
    v_mul_f32 v110, v94, v58
    v_mul_f32 v111, v94, v59
    v_mul_f32 v112, v96, v62
    v_mul_f32 v113, v96, v63
    v_mul_f32 v114, v98, v66
    v_mul_f32 v115, v98, v67
    v_fma_f32 v108, -v93, v55, v108
    v_fmac_f32 v109, v93, v54
    v_fma_f32 v110, -v95, v59, v110
    v_fmac_f32 v111, v95, v58
    v_fma_f32 v112, -v97, v63, v112
    v_fmac_f32 v113, v97, v62
    v_fma_f32 v114, -v99, v67, v114
    v_fmac_f32 v115, v99, v66
    v_cvt_pk_bf16_f32 v104, v108, v109
    v_cvt_pk_bf16_f32 v105, v110, v111
    v_cvt_pk_bf16_f32 v106, v112, v113
    v_cvt_pk_bf16_f32 v107, v114, v115
    s_nop 1
    v_mfma_f32_16x16x32_bf16 v[76:79], v[104:107], v[28:31], 0
    v_mfma_f32_16x16x32_bf16 v[80:83], v[104:107], v[32:35], 0
    v_mul_f32 v108, v84, v52
    v_mul_f32 v109, v84, v53
    v_mul_f32 v110, v86, v56
    v_mul_f32 v111, v86, v57
    v_mul_f32 v112, v88, v60
    v_mul_f32 v113, v88, v61
    v_mul_f32 v114, v90, v64
    v_mul_f32 v115, v90, v65
    v_fma_f32 v108, -v85, v53, v108
    v_fmac_f32 v109, v85, v52
    v_fma_f32 v110, -v87, v57, v110
    v_fmac_f32 v111, v87, v56
    v_fma_f32 v112, -v89, v61, v112
    v_fmac_f32 v113, v89, v60
    v_fma_f32 v114, -v91, v65, v114
    v_fmac_f32 v115, v91, v64
    v_cvt_pk_bf16_f32 v100, v108, v109
    v_cvt_pk_bf16_f32 v101, v110, v111
    v_cvt_pk_bf16_f32 v102, v112, v113
    v_cvt_pk_bf16_f32 v103, v114, v115
    s_nop 1
    v_mfma_f32_16x16x32_bf16 v[68:71], v[100:103], v[28:31], 0
    v_mfma_f32_16x16x32_bf16 v[72:75], v[100:103], v[32:35], 0
    s_bitcmp1_b32 s44, 0
    s_cselect_b32 s84, s30, s28
    s_cselect_b32 s85, s31, s29
    s_mov_b32 s48, 0x07060302
    v_mov_b32 v56, 0x00010001
    v_mov_b32 v52, 0x10000
    v_mul_f32 v108, v76, v36
    v_mul_f32 v109, v76, v37
    v_mul_f32 v110, v77, v38
    v_mul_f32 v111, v77, v39
    v_mul_f32 v112, v78, v40
    v_mul_f32 v113, v78, v41
    v_mul_f32 v114, v79, v42
    v_mul_f32 v115, v79, v43
    v_fma_f32 v108, -v80, v37, v108
    v_fmac_f32 v109, v80, v36
    v_fma_f32 v110, -v81, v39, v110
    v_fmac_f32 v111, v81, v38
    v_fma_f32 v112, -v82, v41, v112
    v_fmac_f32 v113, v82, v40
    v_fma_f32 v114, -v83, v43, v114
    v_fmac_f32 v115, v83, v42
    v_cvt_pk_bf16_f32 v104, v108, v109
    v_cvt_pk_bf16_f32 v105, v110, v111
    v_cvt_pk_bf16_f32 v106, v112, v113
    v_cvt_pk_bf16_f32 v107, v114, v115
    s_nop 1
    v_mfma_f32_16x16x32_bf16 v[92:95], v[44:47], v[104:107], 0
    v_mfma_f32_16x16x32_bf16 v[96:99], v[48:51], v[104:107], 0
    v_mul_f32 v108, v68, v36
    v_mul_f32 v109, v68, v37
    v_mul_f32 v110, v69, v38
    v_mul_f32 v111, v69, v39
    v_mul_f32 v112, v70, v40
    v_mul_f32 v113, v70, v41
    v_mul_f32 v114, v71, v42
    v_mul_f32 v115, v71, v43
    v_fma_f32 v108, -v72, v37, v108
    v_fmac_f32 v109, v72, v36
    v_fma_f32 v110, -v73, v39, v110
    v_fmac_f32 v111, v73, v38
    v_fma_f32 v112, -v74, v41, v112
    v_fmac_f32 v113, v74, v40
    v_fma_f32 v114, -v75, v43, v114
    v_fmac_f32 v115, v75, v42
    v_cvt_pk_bf16_f32 v100, v108, v109
    v_cvt_pk_bf16_f32 v101, v110, v111
    v_cvt_pk_bf16_f32 v102, v112, v113
    v_cvt_pk_bf16_f32 v103, v114, v115
    s_nop 1
    v_mfma_f32_16x16x32_bf16 v[84:87], v[44:47], v[100:103], 0
    v_mfma_f32_16x16x32_bf16 v[88:91], v[48:51], v[100:103], 0
    v_add_u32 v92, v52, v92
    v_add_u32 v93, v52, v93
    v_add_u32 v94, v52, v94
    v_add_u32 v95, v52, v95
    v_add_u32 v96, v52, v96
    v_add_u32 v97, v52, v97
    v_add_u32 v98, v52, v98
    v_add_u32 v99, v52, v99
    v_perm_b32 v117, v93, v92, s48
    v_perm_b32 v119, v95, v94, s48
    v_perm_b32 v121, v97, v96, s48
    v_perm_b32 v123, v99, v98, s48
    v_bfi_b32 v117, v56, s85, v117
    v_bfi_b32 v119, v56, s85, v119
    v_bfi_b32 v121, v56, s85, v121
    v_bfi_b32 v123, v56, s85, v123
    v_add_u32 v84, v52, v84
    v_add_u32 v85, v52, v85
    v_add_u32 v86, v52, v86
    v_add_u32 v87, v52, v87
    v_add_u32 v88, v52, v88
    v_add_u32 v89, v52, v89
    v_add_u32 v90, v52, v90
    v_add_u32 v91, v52, v91
    v_perm_b32 v116, v85, v84, s48
    v_perm_b32 v118, v87, v86, s48
    v_perm_b32 v120, v89, v88, s48
    v_perm_b32 v122, v91, v90, s48
    v_bfi_b32 v116, v56, s84, v116
    v_bfi_b32 v118, v56, s84, v118
    v_bfi_b32 v120, v56, s84, v120
    v_bfi_b32 v122, v56, s84, v122
    ds_write_b64 v6, v[116:117] offset:0
    ds_write_b64 v6, v[118:119] offset:1280
    ds_write_b64 v6, v[120:121] offset:2560
    ds_write_b64 v6, v[122:123] offset:3840
    s_waitcnt lgkmcnt(0)
    s_lshl_b32 s51, s52, 11
    v_and_b32 v4, 15, v1
    v_lshrrev_b32 v5, 4, v1
    v_lshlrev_b32 v4, 6, v4
    v_lshl_add_u32 v4, v5, 4, v4
    buffer_load_dwordx4 v[8:11], v4, s[4:7], s51 offen
    buffer_load_dwordx4 v[12:15], v4, s[4:7], s51 offen offset:1024
    s_barrier
    ds_read_b128 v[16:19], v7
    ds_read_b128 v[20:23], v7 offset:1280
    s_waitcnt lgkmcnt(1)
    buffer_store_dwordx4 v[16:19], v3, s[8:11], s62 offen sc0 sc1
    s_waitcnt lgkmcnt(0)
    buffer_store_dwordx4 v[20:23], v3, s[8:11], s62 offen offset:2048 sc0 sc1
    v_mov_b32 v7, v4
    v_and_b32 v6, 15, v1
    v_lshrrev_b32 v5, 4, v1
    s_and_b32 s45, s2, 7
    s_lshl_b32 s45, s45, 7
    s_add_u32 s50, s45, 4096
    v_mov_b32 v72, 0
    buffer_load_dwordx4 v[76:79], v72, s[8:11], s50 offen sc0 sc1
    s_lshl_b32 s83, s2, 3
    s_add_u32 s83, s83, 98304
    v_lshlrev_b32 v4, 12, v5
    s_mov_b32 s46, 1114112
    v_mul_lo_u32 v3, v5, s46
    v_lshrrev_b32 v80, 3, v6
    v_lshlrev_b32 v80, 15, v80
    v_add_u32 v3, v3, v80
    v_and_b32 v80, 7, v6
    v_lshl_add_u32 v3, v80, 4, v3
    v_mul_u32_u24 v80, 576, v5
    v_lshl_add_u32 v80, v6, 2, v80
    s_mul_i32 s45, s44, 2368
    s_add_u32 s45, s45, 27648
    v_mul_u32_u24 v5, 4736, v5
    v_lshl_add_u32 v5, v6, 4, v5
    v_add_u32 v6, s45, v80
    s_lshr_b32 s45, s44, 1
    s_lshl_b32 s45, s45, 6
    s_lshl_b32 s46, s44, 8
    s_add_u32 s45, s45, s46
    s_add_u32 s45, s45, 27648
    v_add_u32 v5, s45, v5
    s_waitcnt vmcnt(3)
    v_lshlrev_b32 v24, 16, v8
    v_and_b32 v25, 0xffff0000, v8
    v_lshlrev_b32 v26, 16, v9
    v_and_b32 v27, 0xffff0000, v9
    v_lshlrev_b32 v28, 16, v10
    v_and_b32 v29, 0xffff0000, v10
    v_lshlrev_b32 v30, 16, v11
    v_and_b32 v31, 0xffff0000, v11
    v_lshlrev_b32 v32, 16, v12
    v_and_b32 v33, 0xffff0000, v12
    v_lshlrev_b32 v34, 16, v13
    v_and_b32 v35, 0xffff0000, v13
    v_lshlrev_b32 v36, 16, v14
    v_and_b32 v37, 0xffff0000, v14
    v_lshlrev_b32 v38, 16, v15
    v_and_b32 v39, 0xffff0000, v15
    ds_read_b128 v[40:43], v2 offset:11264
    ds_read_b128 v[44:47], v2 offset:12288
    ds_read_b128 v[48:51], v2 offset:13312
    ds_read_b128 v[52:55], v2 offset:14336
    v_mov_b32 v88, s55
    v_mov_b32 v89, s56
    v_mov_b32 v90, 0xbfb8aa3b
    v_fma_f32 v8, v24, v88, v89
    v_fma_f32 v9, v25, v88, v89
    v_fma_f32 v10, v26, v88, v89
    v_fma_f32 v11, v27, v88, v89
    v_mul_f32 v92, v90, v8
    v_mul_f32 v93, v90, v9
    v_mul_f32 v94, v90, v10
    v_mul_f32 v95, v90, v11
    v_exp_f32 v92, v92
    v_exp_f32 v93, v93
    v_exp_f32 v94, v94
    v_exp_f32 v95, v95
    v_add_f32 v92, 1.0, v92
    v_add_f32 v93, 1.0, v93
    v_add_f32 v94, 1.0, v94
    v_add_f32 v95, 1.0, v95
    v_rcp_f32 v92, v92
    v_rcp_f32 v93, v93
    v_rcp_f32 v94, v94
    v_rcp_f32 v95, v95
    v_mul_f32 v8, v8, v92
    v_mul_f32 v9, v9, v93
    v_mul_f32 v10, v10, v94
    v_mul_f32 v11, v11, v95
    v_fma_f32 v12, v28, v88, v89
    v_fma_f32 v13, v29, v88, v89
    v_fma_f32 v14, v30, v88, v89
    v_fma_f32 v15, v31, v88, v89
    v_mul_f32 v92, v90, v12
    v_mul_f32 v93, v90, v13
    v_mul_f32 v94, v90, v14
    v_mul_f32 v95, v90, v15
    v_exp_f32 v92, v92
    v_exp_f32 v93, v93
    v_exp_f32 v94, v94
    v_exp_f32 v95, v95
    v_add_f32 v92, 1.0, v92
    v_add_f32 v93, 1.0, v93
    v_add_f32 v94, 1.0, v94
    v_add_f32 v95, 1.0, v95
    v_rcp_f32 v92, v92
    v_rcp_f32 v93, v93
    v_rcp_f32 v94, v94
    v_rcp_f32 v95, v95
    v_mul_f32 v12, v12, v92
    v_mul_f32 v13, v13, v93
    v_mul_f32 v14, v14, v94
    v_mul_f32 v15, v15, v95
    v_fma_f32 v16, v32, v88, v89
    v_fma_f32 v17, v33, v88, v89
    v_fma_f32 v18, v34, v88, v89
    v_fma_f32 v19, v35, v88, v89
    v_mul_f32 v92, v90, v16
    v_mul_f32 v93, v90, v17
    v_mul_f32 v94, v90, v18
    v_mul_f32 v95, v90, v19
    v_exp_f32 v92, v92
    v_exp_f32 v93, v93
    v_exp_f32 v94, v94
    v_exp_f32 v95, v95
    v_add_f32 v92, 1.0, v92
    v_add_f32 v93, 1.0, v93
    v_add_f32 v94, 1.0, v94
    v_add_f32 v95, 1.0, v95
    v_rcp_f32 v92, v92
    v_rcp_f32 v93, v93
    v_rcp_f32 v94, v94
    v_rcp_f32 v95, v95
    v_mul_f32 v16, v16, v92
    v_mul_f32 v17, v17, v93
    v_mul_f32 v18, v18, v94
    v_mul_f32 v19, v19, v95
    v_fma_f32 v20, v36, v88, v89
    v_fma_f32 v21, v37, v88, v89
    v_fma_f32 v22, v38, v88, v89
    v_fma_f32 v23, v39, v88, v89
    v_mul_f32 v92, v90, v20
    v_mul_f32 v93, v90, v21
    v_mul_f32 v94, v90, v22
    v_mul_f32 v95, v90, v23
    v_exp_f32 v92, v92
    v_exp_f32 v93, v93
    v_exp_f32 v94, v94
    v_exp_f32 v95, v95
    v_add_f32 v92, 1.0, v92
    v_add_f32 v93, 1.0, v93
    v_add_f32 v94, 1.0, v94
    v_add_f32 v95, 1.0, v95
    v_rcp_f32 v92, v92
    v_rcp_f32 v93, v93
    v_rcp_f32 v94, v94
    v_rcp_f32 v95, v95
    v_mul_f32 v20, v20, v92
    v_mul_f32 v21, v21, v93
    v_mul_f32 v22, v22, v94
    v_mul_f32 v23, v23, v95
    v_bfe_u32 v91, v1, 1, 3
    v_and_b32 v93, 1, v1
    v_cmp_eq_u32 vcc, 1, v93
    v_lshrrev_b32 v92, 4, v1
    v_lshlrev_b32 v92, 1, v92
    v_lshlrev_b32 v93, 8, v91
    v_add_u32 v93, s2, v93
    v_add_u32 v88, 0, v92
    v_mul_lo_u32 v93, v93, v88
    v_and_b32 v93, 2047, v93
    v_cvt_f32_u32 v93, v93
    v_mul_f32 v93, 0x3a000000, v93
    v_cos_f32 v88, v93
    v_sin_f32 v89, v93
    s_nop 0
    v_sub_f32 v90, 0, v89
    v_cndmask_b32 v90, v90, v88, vcc
    v_cndmask_b32 v88, v88, v89, vcc
    v_cvt_pk_bf16_f32 v124, v88, v90
    v_lshlrev_b32 v93, 8, v91
    v_add_u32 v93, s2, v93
    v_add_u32 v88, 1, v92
    v_mul_lo_u32 v93, v93, v88
    v_and_b32 v93, 2047, v93
    v_cvt_f32_u32 v93, v93
    v_mul_f32 v93, 0x3a000000, v93
    v_cos_f32 v88, v93
    v_sin_f32 v89, v93
    s_nop 0
    v_sub_f32 v90, 0, v89
    v_cndmask_b32 v90, v90, v88, vcc
    v_cndmask_b32 v88, v88, v89, vcc
    v_cvt_pk_bf16_f32 v125, v88, v90
    s_mov_b32 s75, 0
    s_waitcnt vmcnt(0)
    s_branch L_pollI_chk
L_pollI:
    buffer_load_dwordx4 v[76:79], v72, s[8:11], s50 offen sc0 sc1
    s_waitcnt vmcnt(0)
L_pollI_chk:
    v_cmp_ne_u32 vcc, s68, v79
    s_nop 4
    s_cbranch_vccz L_pollI_done
    s_add_u32 s75, s75, 1
    s_cmp_gt_u32 s75, 20000
    s_cbranch_scc1 L_pollI_done
    s_sleep 4
    s_branch L_pollI
L_pollI_done:
    v_readfirstlane_b32 s80, v76
    v_readfirstlane_b32 s81, v77
    v_readfirstlane_b32 s82, v78
    s_and_b32 s78, s80, 0x7ff
    s_sub_u32 s78, 2047, s78
    s_lshr_b32 s45, s80, 16
    s_and_b32 s46, s45, 0x7fff
    s_xor_b32 s47, s45, 0xffff
    s_bitcmp1_b32 s45, 15
    s_cselect_b32 s45, s46, s47
    s_lshl_b32 s45, s45, 16
    v_mov_b32 v76, s45
    v_mul_f32 v76, 0xbfb8aa3b, v76
    v_exp_f32 v76, v76
    s_nop 0
    v_add_f32 v76, 1.0, v76
    v_rcp_f32 v76, v76
    s_nop 0
    v_cvt_pk_bf16_f32 v76, v76, v76
    v_and_b32 v76, 0xffff0000, v76
    s_nop 0
    v_readfirstlane_b32 s79, v76
    v_mov_b32 v117, s68
    v_mov_b32 v119, s68
    v_mov_b32 v113, 0x00010001
    s_mov_b32 s75, 0
L_pollB:
    buffer_load_dwordx4 v[72:75], v3, s[8:11], s65 offen sc0 sc1
    buffer_load_dwordx4 v[76:79], v3, s[8:11], s66 offen sc0 sc1
    s_cmp_lg_u32 s44, 7
    s_cbranch_scc1 L_pollB_nn
    buffer_load_dwordx2 v[116:117], v4, s[8:11], s83 offen sc0 sc1
    buffer_load_dwordx2 v[118:119], v4, s[8:11], s83 offen offset:2048 sc0 sc1
L_pollB_nn:
    s_waitcnt vmcnt(0)
    v_xor_b32 v72, s28, v72
    v_xor_b32 v73, s29, v73
    v_xor_b32 v74, s30, v74
    v_xor_b32 v75, s31, v75
    v_xor_b32 v76, s28, v76
    v_xor_b32 v77, s29, v77
    v_xor_b32 v78, s30, v78
    v_xor_b32 v79, s31, v79
    v_or_b32 v104, v72, v73
    v_or_b32 v106, v74, v75
    v_or_b32 v108, v76, v77
    v_or_b32 v110, v78, v79
    v_or_b32 v104, v104, v106
    v_or_b32 v108, v108, v110
    v_or_b32 v104, v104, v108
    v_and_b32 v104, v113, v104
    v_xor_b32 v105, s68, v117
    v_xor_b32 v106, s68, v119
    v_or_b32 v104, v104, v105
    v_or_b32 v104, v104, v106
    v_cmp_ne_u32 vcc, 0, v104
    s_nop 4
    s_cbranch_vccz L_pollB_done
    s_add_u32 s75, s75, 1
    s_cmp_gt_u32 s75, 20000
    s_cbranch_scc1 L_pollB_done
    s_sleep 4
    s_branch L_pollB
L_pollB_done:
    v_mov_b32 v80, v72
    v_mov_b32 v81, v76
    v_mov_b32 v82, v73
    v_mov_b32 v83, v77
    v_mov_b32 v84, v74
    v_mov_b32 v85, v78
    v_mov_b32 v86, v75
    v_mov_b32 v87, v79
    v_mfma_f32_16x16x16_bf16 v[88:91], v[124:125], v[80:81], 0
    v_mfma_f32_16x16x16_bf16 v[92:95], v[124:125], v[82:83], 0
    v_mfma_f32_16x16x16_bf16 v[96:99], v[124:125], v[84:85], 0
    v_mfma_f32_16x16x16_bf16 v[100:103], v[124:125], v[86:87], 0
    s_nop 4
    v_cvt_pk_bf16_f32 v104, v88, v89
    v_cvt_pk_bf16_f32 v105, v92, v93
    v_cvt_pk_bf16_f32 v106, v96, v97
    v_cvt_pk_bf16_f32 v107, v100, v101
    ds_write_b128 v5, v[104:107] offset:0
    v_cvt_pk_bf16_f32 v108, v90, v91
    v_cvt_pk_bf16_f32 v109, v94, v95
    v_cvt_pk_bf16_f32 v110, v98, v99
    v_cvt_pk_bf16_f32 v111, v102, v103
    ds_write_b128 v5, v[108:111] offset:2368
    s_cmp_lg_u32 s44, 7
    s_cbranch_scc1 Lp3n_1210
    v_mov_b32 v112, v116
    v_mov_b32 v113, v118
    s_nop 1
    v_mfma_f32_16x16x16_bf16 v[116:119], v[124:125], v[112:113], 0
    v_lshrrev_b32 v72, 4, v1
    v_mul_u32_u24 v72, 4736, v72
    v_add_u32 v72, 29952, v72
    v_and_b32 v73, 15, v1
    v_cmp_eq_u32 vcc, 0, v73
    s_and_saveexec_b64 s[76:77], vcc
    s_nop 1
    v_cvt_pk_bf16_f32 v116, v116, v117
    v_cvt_pk_bf16_f32 v117, v118, v119
    ds_write_b32 v72, v116
    ds_write_b32 v72, v117 offset:2368
    s_mov_b64 exec, s[76:77]
Lp3n_1210:
    s_waitcnt lgkmcnt(0)
    s_barrier
    ds_read2_b32 v[72:73], v6 offset0:0 offset1:32
    ds_read2_b32 v[74:75], v6 offset0:64 offset1:96
    ds_read2_b32 v[76:77], v6 offset0:16 offset1:48
    ds_read2_b32 v[78:79], v6 offset0:80 offset1:112
    s_mul_i32 s45, s44, 2368
    s_add_u32 s45, s45, 27648
    v_mov_b32 v3, s45
    ds_read_b32 v4, v3
    ds_read_b32 v5, v3 offset:2304
    ds_read_b128 v[56:59], v2 offset:15360
    ds_read_b128 v[60:63], v2 offset:16384
    ds_read_b128 v[64:67], v2 offset:17408
    ds_read_b128 v[68:71], v2 offset:18432
    s_waitcnt lgkmcnt(8)
    v_mfma_f32_16x16x32_bf16 v[88:91], v[72:75], v[40:43], 0
    v_mfma_f32_16x16x32_bf16 v[92:95], v[72:75], v[44:47], 0
    v_mfma_f32_16x16x32_bf16 v[96:99], v[72:75], v[48:51], 0
    v_mfma_f32_16x16x32_bf16 v[100:103], v[72:75], v[52:55], 0
    s_waitcnt lgkmcnt(6)
    v_mfma_f32_16x16x32_bf16 v[104:107], v[76:79], v[40:43], 0
    v_mfma_f32_16x16x32_bf16 v[108:111], v[76:79], v[44:47], 0
    v_mfma_f32_16x16x32_bf16 v[112:115], v[76:79], v[48:51], 0
    v_mfma_f32_16x16x32_bf16 v[116:119], v[76:79], v[52:55], 0
    s_waitcnt lgkmcnt(4)
    v_lshlrev_b32 v4, 16, v4
    v_lshlrev_b32 v5, 16, v5
    v_sub_f32 v3, v5, v4
    v_add_f32 v5, v5, v4
    v_mul_f32 v3, 0x36000000, v3
    v_mul_f32 v5, 0xb6000000, v5
    ds_read_b128 v[40:43], v2 offset:23552
    ds_read_b128 v[44:47], v2 offset:24576
    ds_read_b128 v[48:51], v2 offset:25600
    ds_read_b128 v[52:55], v2 offset:26624
    s_waitcnt lgkmcnt(6)
    v_mul_f32 v120, v88, v56
    v_mul_f32 v121, v88, v57
    v_mul_f32 v122, v89, v58
    v_mul_f32 v123, v89, v59
    v_mul_f32 v124, v90, v60
    v_mul_f32 v125, v90, v61
    v_mul_f32 v126, v91, v62
    v_mul_f32 v127, v91, v63
    v_fma_f32 v120, -v92, v57, v120
    v_fmac_f32 v121, v92, v56
    v_fma_f32 v122, -v93, v59, v122
    v_fmac_f32 v123, v93, v58
    v_fma_f32 v124, -v94, v61, v124
    v_fmac_f32 v125, v94, v60
    v_fma_f32 v126, -v95, v63, v126
    v_fmac_f32 v127, v95, v62
    ds_read_b128 v[56:59], v2 offset:19456
    ds_read_b128 v[60:63], v2 offset:20480
    v_cvt_pk_bf16_f32 v72, v120, v121
    v_cvt_pk_bf16_f32 v73, v122, v123
    v_cvt_pk_bf16_f32 v74, v124, v125
    v_cvt_pk_bf16_f32 v75, v126, v127
    s_waitcnt lgkmcnt(6)
    v_mul_f32 v120, v96, v64
    v_mul_f32 v121, v96, v65
    v_mul_f32 v122, v97, v66
    v_mul_f32 v123, v97, v67
    v_mul_f32 v124, v98, v68
    v_mul_f32 v125, v98, v69
    v_mul_f32 v126, v99, v70
    v_mul_f32 v127, v99, v71
    v_fma_f32 v120, -v100, v65, v120
    v_fmac_f32 v121, v100, v64
    v_fma_f32 v122, -v101, v67, v122
    v_fmac_f32 v123, v101, v66
    v_fma_f32 v124, -v102, v69, v124
    v_fmac_f32 v125, v102, v68
    v_fma_f32 v126, -v103, v71, v126
    v_fmac_f32 v127, v103, v70
    ds_read_b128 v[64:67], v2 offset:21504
    ds_read_b128 v[68:71], v2 offset:22528
    v_cvt_pk_bf16_f32 v76, v120, v121
    v_cvt_pk_bf16_f32 v77, v122, v123
    v_cvt_pk_bf16_f32 v78, v124, v125
    v_cvt_pk_bf16_f32 v79, v126, v127
    s_waitcnt lgkmcnt(2)
    v_mul_f32 v120, v104, v56
    v_mul_f32 v121, v104, v57
    v_mul_f32 v122, v105, v58
    v_mul_f32 v123, v105, v59
    v_mul_f32 v124, v106, v60
    v_mul_f32 v125, v106, v61
    v_mul_f32 v126, v107, v62
    v_mul_f32 v127, v107, v63
    v_fma_f32 v120, -v108, v57, v120
    v_fmac_f32 v121, v108, v56
    v_fma_f32 v122, -v109, v59, v122
    v_fmac_f32 v123, v109, v58
    v_fma_f32 v124, -v110, v61, v124
    v_fmac_f32 v125, v110, v60
    v_fma_f32 v126, -v111, v63, v126
    v_fmac_f32 v127, v111, v62
    v_cvt_pk_bf16_f32 v80, v120, v121
    v_cvt_pk_bf16_f32 v81, v122, v123
    v_cvt_pk_bf16_f32 v82, v124, v125
    v_cvt_pk_bf16_f32 v83, v126, v127
    s_waitcnt lgkmcnt(0)
    v_mul_f32 v120, v112, v64
    v_mul_f32 v121, v112, v65
    v_mul_f32 v122, v113, v66
    v_mul_f32 v123, v113, v67
    v_mul_f32 v124, v114, v68
    v_mul_f32 v125, v114, v69
    v_mul_f32 v126, v115, v70
    v_mul_f32 v127, v115, v71
    v_fma_f32 v120, -v116, v65, v120
    v_fmac_f32 v121, v116, v64
    v_fma_f32 v122, -v117, v67, v122
    v_fmac_f32 v123, v117, v66
    v_fma_f32 v124, -v118, v69, v124
    v_fmac_f32 v125, v118, v68
    v_fma_f32 v126, -v119, v71, v126
    v_fmac_f32 v127, v119, v70
    v_cvt_pk_bf16_f32 v84, v120, v121
    v_cvt_pk_bf16_f32 v85, v122, v123
    v_cvt_pk_bf16_f32 v86, v124, v125
    v_cvt_pk_bf16_f32 v87, v126, v127
    s_waitcnt lgkmcnt(0)
    v_mfma_f32_16x16x32_bf16 v[88:91], v[72:75], v[40:43], 0
    v_mfma_f32_16x16x32_bf16 v[88:91], v[80:83], v[48:51], v[88:91]
    v_mfma_f32_16x16x32_bf16 v[96:99], v[76:79], v[40:43], 0
    v_mfma_f32_16x16x32_bf16 v[96:99], v[84:87], v[48:51], v[96:99]
    v_mfma_f32_16x16x32_bf16 v[92:95], v[72:75], v[44:47], 0
    v_mfma_f32_16x16x32_bf16 v[92:95], v[80:83], v[52:55], v[92:95]
    v_mfma_f32_16x16x32_bf16 v[100:103], v[76:79], v[44:47], 0
    v_mfma_f32_16x16x32_bf16 v[100:103], v[84:87], v[52:55], v[100:103]
    s_cmp_eq_u32 s78, s52
    s_cbranch_scc1 L_ownwave
    v_add_f32 v88, v88, v3
    v_add_f32 v89, v89, v5
    v_add_f32 v90, v90, v3
    v_add_f32 v91, v91, v5
    v_add_f32 v96, v96, v3
    v_add_f32 v97, v97, v5
    v_add_f32 v98, v98, v3
    v_add_f32 v99, v99, v5
    v_fmac_f32 v24, v88, v8
    v_fmac_f32 v25, v89, v9
    v_fmac_f32 v26, v90, v10
    v_fmac_f32 v27, v91, v11
    v_fmac_f32 v28, v96, v12
    v_fmac_f32 v29, v97, v13
    v_fmac_f32 v30, v98, v14
    v_fmac_f32 v31, v99, v15
    v_cvt_pk_bf16_f32 v120, v24, v25
    v_cvt_pk_bf16_f32 v121, v26, v27
    v_cvt_pk_bf16_f32 v122, v28, v29
    v_cvt_pk_bf16_f32 v123, v30, v31
    buffer_store_dwordx4 v[120:123], v7, s[16:19], s51 offen offset:0 sc0 sc1
    v_add_f32 v92, v92, v3
    v_add_f32 v93, v93, v5
    v_add_f32 v94, v94, v3
    v_add_f32 v95, v95, v5
    v_add_f32 v100, v100, v3
    v_add_f32 v101, v101, v5
    v_add_f32 v102, v102, v3
    v_add_f32 v103, v103, v5
    v_fmac_f32 v32, v92, v16
    v_fmac_f32 v33, v93, v17
    v_fmac_f32 v34, v94, v18
    v_fmac_f32 v35, v95, v19
    v_fmac_f32 v36, v100, v20
    v_fmac_f32 v37, v101, v21
    v_fmac_f32 v38, v102, v22
    v_fmac_f32 v39, v103, v23
    v_cvt_pk_bf16_f32 v124, v32, v33
    v_cvt_pk_bf16_f32 v125, v34, v35
    v_cvt_pk_bf16_f32 v126, v36, v37
    v_cvt_pk_bf16_f32 v127, v38, v39
    buffer_store_dwordx4 v[124:127], v7, s[16:19], s51 offen offset:1024 sc0 sc1
    s_and_b32 s45, s78, 255
    s_cmp_eq_u32 s45, s2
    s_cbranch_scc0 L_p3done
L_ownwave:
    s_setprio 3
    v_lshlrev_b32 v73, 2, v0
    s_lshl_b32 s45, s78, 11
    buffer_load_dword v78, v73, s[4:7], s45 offen
    v_lshlrev_b32 v72, 3, v0
    v_mov_b32 v75, 0xff
    v_mov_b32 v77, s69
    v_mov_b32 v79, 0xbfb8aa3b
    s_mov_b32 s75, 0
L_pollY:
    s_mov_b32 s46, 11730944
    buffer_load_dwordx2 v[40:41], v72, s[8:11], s46 offen sc0 sc1
    s_mov_b32 s46, 11735040
    buffer_load_dwordx2 v[42:43], v72, s[8:11], s46 offen sc0 sc1
    s_mov_b32 s46, 11739136
    buffer_load_dwordx2 v[44:45], v72, s[8:11], s46 offen sc0 sc1
    s_mov_b32 s46, 11743232
    buffer_load_dwordx2 v[46:47], v72, s[8:11], s46 offen sc0 sc1
    s_mov_b32 s46, 11747328
    buffer_load_dwordx2 v[48:49], v72, s[8:11], s46 offen sc0 sc1
    s_mov_b32 s46, 11751424
    buffer_load_dwordx2 v[50:51], v72, s[8:11], s46 offen sc0 sc1
    s_mov_b32 s46, 11755520
    buffer_load_dwordx2 v[52:53], v72, s[8:11], s46 offen sc0 sc1
    s_mov_b32 s46, 11759616
    buffer_load_dwordx2 v[54:55], v72, s[8:11], s46 offen sc0 sc1
    s_mov_b32 s46, 11763712
    buffer_load_dwordx2 v[56:57], v72, s[8:11], s46 offen sc0 sc1
    s_mov_b32 s46, 11767808
    buffer_load_dwordx2 v[58:59], v72, s[8:11], s46 offen sc0 sc1
    s_mov_b32 s46, 11771904
    buffer_load_dwordx2 v[60:61], v72, s[8:11], s46 offen sc0 sc1
    s_mov_b32 s46, 11776000
    buffer_load_dwordx2 v[62:63], v72, s[8:11], s46 offen sc0 sc1
    s_mov_b32 s46, 11780096
    buffer_load_dwordx2 v[64:65], v72, s[8:11], s46 offen sc0 sc1
    s_mov_b32 s46, 11784192
    buffer_load_dwordx2 v[66:67], v72, s[8:11], s46 offen sc0 sc1
    s_waitcnt vmcnt(0)
    v_xor_b32 v40, v77, v40
    v_xor_b32 v41, v77, v41
    v_xor_b32 v42, v77, v42
    v_xor_b32 v43, v77, v43
    v_xor_b32 v44, v77, v44
    v_xor_b32 v45, v77, v45
    v_xor_b32 v46, v77, v46
    v_xor_b32 v47, v77, v47
    v_xor_b32 v48, v77, v48
    v_xor_b32 v49, v77, v49
    v_xor_b32 v50, v77, v50
    v_xor_b32 v51, v77, v51
    v_xor_b32 v52, v77, v52
    v_xor_b32 v53, v77, v53
    v_xor_b32 v54, v77, v54
    v_xor_b32 v55, v77, v55
    v_xor_b32 v56, v77, v56
    v_xor_b32 v57, v77, v57
    v_xor_b32 v58, v77, v58
    v_xor_b32 v59, v77, v59
    v_xor_b32 v60, v77, v60
    v_xor_b32 v61, v77, v61
    v_xor_b32 v62, v77, v62
    v_xor_b32 v63, v77, v63
    v_xor_b32 v64, v77, v64
    v_xor_b32 v65, v77, v65
    v_xor_b32 v66, v77, v66
    v_xor_b32 v67, v77, v67
    v_or_b32 v76, v40, v41
    v_or_b32 v80, v42, v43
    v_or_b32 v76, v76, v80
    v_or_b32 v80, v44, v45
    v_or_b32 v76, v76, v80
    v_or_b32 v80, v46, v47
    v_or_b32 v76, v76, v80
    v_or_b32 v80, v48, v49
    v_or_b32 v76, v76, v80
    v_or_b32 v80, v50, v51
    v_or_b32 v76, v76, v80
    v_or_b32 v80, v52, v53
    v_or_b32 v76, v76, v80
    v_or_b32 v80, v54, v55
    v_or_b32 v76, v76, v80
    v_or_b32 v80, v56, v57
    v_or_b32 v76, v76, v80
    v_or_b32 v80, v58, v59
    v_or_b32 v76, v76, v80
    v_or_b32 v80, v60, v61
    v_or_b32 v76, v76, v80
    v_or_b32 v80, v62, v63
    v_or_b32 v76, v76, v80
    v_or_b32 v80, v64, v65
    v_or_b32 v76, v76, v80
    v_or_b32 v80, v66, v67
    v_or_b32 v76, v76, v80
    v_and_b32 v76, v75, v76
    v_cmp_ne_u32 vcc, 0, v76
    s_nop 4
    s_cbranch_vccz L_pollY_done
    s_add_u32 s75, s75, 1
    s_cmp_gt_u32 s75, 20000
    s_cbranch_scc1 L_pollY_done
    s_sleep 2
    s_branch L_pollY
L_pollY_done:
    v_add_f32 v40, v40, v42
    v_add_f32 v41, v41, v43
    v_add_f32 v44, v44, v46
    v_add_f32 v45, v45, v47
    v_add_f32 v48, v48, v50
    v_add_f32 v49, v49, v51
    v_add_f32 v52, v52, v54
    v_add_f32 v53, v53, v55
    v_add_f32 v56, v56, v58
    v_add_f32 v57, v57, v59
    v_add_f32 v60, v60, v62
    v_add_f32 v61, v61, v63
    v_add_f32 v64, v64, v66
    v_add_f32 v65, v65, v67
    v_add_f32 v40, v40, v44
    v_add_f32 v41, v41, v45
    v_add_f32 v48, v48, v52
    v_add_f32 v49, v49, v53
    v_add_f32 v56, v56, v60
    v_add_f32 v57, v57, v61
    v_add_f32 v40, v40, v48
    v_add_f32 v41, v41, v49
    v_add_f32 v56, v56, v64
    v_add_f32 v57, v57, v65
    v_add_f32 v40, v40, v56
    v_add_f32 v41, v41, v57
    v_cvt_pk_bf16_f32 v84, v40, v41
    v_lshlrev_b32 v82, 16, v78
    v_and_b32 v83, 0xffff0000, v78
    v_and_b32 v41, 0xffff0000, v84
    v_lshlrev_b32 v40, 16, v84
    v_subrev_f32 v82, s81, v82
    v_subrev_f32 v83, s81, v83
    v_mul_f32 v40, s79, v40
    v_mul_f32 v41, s79, v41
    v_cvt_pk_bf16_f32 v85, v82, v83
    v_cvt_pk_bf16_f32 v84, v40, v41
    v_and_b32 v83, 0xffff0000, v85
    v_lshlrev_b32 v82, 16, v85
    v_and_b32 v41, 0xffff0000, v84
    v_lshlrev_b32 v40, 16, v84
    v_mul_f32 v82, s82, v82
    v_mul_f32 v83, s82, v83
    v_cvt_pk_bf16_f32 v85, v82, v83
    v_and_b32 v83, 0xffff0000, v85
    v_lshlrev_b32 v82, 16, v85
    v_add_f32 v82, v82, v40
    v_add_f32 v83, v83, v41
    v_cvt_pk_bf16_f32 v84, v82, v83
    v_and_b32 v83, 0xffff0000, v84
    v_lshlrev_b32 v82, 16, v84
    v_mul_f32 v84, v79, v82
    v_mul_f32 v85, v79, v83
    v_exp_f32 v84, v84
    v_exp_f32 v85, v85
    v_add_f32 v84, 1.0, v84
    v_add_f32 v85, 1.0, v85
    v_rcp_f32 v84, v84
    v_rcp_f32 v85, v85
    v_mul_f32 v82, v82, v84
    v_mul_f32 v83, v83, v85
    v_cvt_pk_bf16_f32 v84, v82, v83
    v_and_b32 v83, 0xffff0000, v84
    v_lshlrev_b32 v82, 16, v84
    v_add_u32 v74, 46592, v72
    ds_write_b64 v74, v[82:83]
    s_waitcnt lgkmcnt(0)
    s_barrier
    s_cmp_eq_u32 s78, s52
    s_cbranch_scc0 L_p3done
    v_and_b32 v72, 15, v1
    v_lshrrev_b32 v73, 4, v1
    v_lshlrev_b32 v72, 7, v72
    v_lshl_add_u32 v72, v73, 5, v72
    v_add_u32 v72, 46592, v72
    ds_read_b128 v[8:11], v72 offset:0
    ds_read_b128 v[12:15], v72 offset:16
    ds_read_b128 v[16:19], v72 offset:2048
    ds_read_b128 v[20:23], v72 offset:2064
    v_mov_b32 v72, 0
    v_mov_b32 v73, s68
    s_mov_b64 exec, 1
    buffer_store_dword v73, v72, s[8:11], 0 offen
    s_mov_b64 exec, -1
    s_waitcnt lgkmcnt(0)
    v_add_f32 v88, v88, v3
    v_add_f32 v89, v89, v5
    v_add_f32 v90, v90, v3
    v_add_f32 v91, v91, v5
    v_add_f32 v96, v96, v3
    v_add_f32 v97, v97, v5
    v_add_f32 v98, v98, v3
    v_add_f32 v99, v99, v5
    v_fmac_f32 v24, v88, v8
    v_fmac_f32 v25, v89, v9
    v_fmac_f32 v26, v90, v10
    v_fmac_f32 v27, v91, v11
    v_fmac_f32 v28, v96, v12
    v_fmac_f32 v29, v97, v13
    v_fmac_f32 v30, v98, v14
    v_fmac_f32 v31, v99, v15
    v_cvt_pk_bf16_f32 v120, v24, v25
    v_cvt_pk_bf16_f32 v121, v26, v27
    v_cvt_pk_bf16_f32 v122, v28, v29
    v_cvt_pk_bf16_f32 v123, v30, v31
    buffer_store_dwordx4 v[120:123], v7, s[16:19], s51 offen offset:0 sc0 sc1
    v_add_f32 v92, v92, v3
    v_add_f32 v93, v93, v5
    v_add_f32 v94, v94, v3
    v_add_f32 v95, v95, v5
    v_add_f32 v100, v100, v3
    v_add_f32 v101, v101, v5
    v_add_f32 v102, v102, v3
    v_add_f32 v103, v103, v5
    v_fmac_f32 v32, v92, v16
    v_fmac_f32 v33, v93, v17
    v_fmac_f32 v34, v94, v18
    v_fmac_f32 v35, v95, v19
    v_fmac_f32 v36, v100, v20
    v_fmac_f32 v37, v101, v21
    v_fmac_f32 v38, v102, v22
    v_fmac_f32 v39, v103, v23
    v_cvt_pk_bf16_f32 v124, v32, v33
    v_cvt_pk_bf16_f32 v125, v34, v35
    v_cvt_pk_bf16_f32 v126, v36, v37
    v_cvt_pk_bf16_f32 v127, v38, v39
    buffer_store_dwordx4 v[124:127], v7, s[16:19], s51 offen offset:1024 sc0 sc1
L_p3done:
    s_branch L_fin
L_second:
    s_load_dword s68, s[8:9], 0
    s_cmp_ge_u32 s2, 480
    s_cbranch_scc1 L_spare
    s_waitcnt lgkmcnt(0)
    s_add_u32 s68, s68, 1
    s_and_b32 s69, s68, 0xff
    s_bfe_u32 s45, s69, 65536
    s_bfe_u32 s46, s69, 65537
    s_lshl_b32 s46, s46, 16
    s_or_b32 s70, s45, s46
    s_bfe_u32 s45, s69, 65538
    s_bfe_u32 s46, s69, 65539
    s_lshl_b32 s46, s46, 16
    s_or_b32 s71, s45, s46
    s_bfe_u32 s45, s69, 65540
    s_bfe_u32 s46, s69, 65541
    s_lshl_b32 s46, s46, 16
    s_or_b32 s72, s45, s46
    s_bfe_u32 s45, s69, 65542
    s_bfe_u32 s46, s69, 65543
    s_lshl_b32 s46, s46, 16
    s_or_b32 s73, s45, s46
    s_sub_u32 s3, s2, 256
    s_and_b32 s58, s3, 3
    s_lshr_b32 s59, s3, 2
    s_lshr_b32 s60, s3, 4
    s_and_b32 s61, s3, 15
    v_lshrrev_b32 v6, 3, v1
    v_mul_u32_u24 v6, 7168, v6
    v_and_b32 v7, 7, v1
    v_bfe_u32 v3, v1, 4, 1
    v_lshlrev_b32 v3, 1, v3
    v_xor_b32 v7, v7, v3
    v_lshl_add_u32 v6, v7, 4, v6
    v_xor_b32 v5, 64, v6
    s_mul_i32 s47, s58, 1835008
    s_lshl_b32 s45, s59, 7
    s_add_u32 s47, s47, s45
    s_mul_i32 s45, s44, 229376
    s_add_u32 s47, s47, s45
    s_lshl_b32 s48, s44, 12
    s_add_u32 m0, s48, 14336
    s_add_u32 s45, s47, 0
    buffer_load_dwordx4 v6, s[32:35], s45 offen  lds
    s_add_u32 m0, s48, 15360
    s_add_u32 s45, s47, 57344
    buffer_load_dwordx4 v5, s[32:35], s45 offen  lds
    s_add_u32 m0, s48, 16384
    s_add_u32 s45, s47, 114688
    buffer_load_dwordx4 v6, s[32:35], s45 offen  lds
    s_add_u32 m0, s48, 17408
    s_add_u32 s45, s47, 172032
    buffer_load_dwordx4 v5, s[32:35], s45 offen  lds
    s_add_u32 m0, s48, 47104
    s_add_u32 s45, s47, 0
    buffer_load_dwordx4 v6, s[36:39], s45 offen  lds
    s_add_u32 m0, s48, 48128
    s_add_u32 s45, s47, 57344
    buffer_load_dwordx4 v5, s[36:39], s45 offen  lds
    s_add_u32 m0, s48, 49152
    s_add_u32 s45, s47, 114688
    buffer_load_dwordx4 v6, s[36:39], s45 offen  lds
    s_add_u32 m0, s48, 50176
    s_add_u32 s45, s47, 172032
    buffer_load_dwordx4 v5, s[36:39], s45 offen  lds
    v_bfe_u32 v3, v1, 2, 2
    v_lshrrev_b32 v4, 4, v1
    v_lshlrev_b32 v6, 3, v4
    v_add_u32 v6, v6, v3
    v_lshlrev_b32 v6, 7, v6
    v_and_b32 v7, 3, v1
    v_lshl_add_u32 v6, v7, 3, v6
    v_lshrrev_b32 v3, 1, v3
    v_and_b32 v7, 1, v4
    v_lshl_add_u32 v3, v7, 1, v3
    v_lshl_add_u32 v6, v3, 5, v6
    s_lshl_b32 s45, s44, 12
    v_add_u32 v6, s45, v6
    v_xor_b32 v24, 0, v6
    v_xor_b32 v25, 32, v6
    v_xor_b32 v26, 64, v6
    v_xor_b32 v27, 96, v6
    v_lshlrev_b32 v28, 4, v4
    v_and_b32 v29, 15, v1
    v_lshlrev_b32 v29, 2, v29
    s_lshl_b32 s45, s44, 9
    s_add_u32 s45, s45, 0
    v_add_u32 v29, s45, v29
    s_waitcnt vmcnt(0)
    ds_read_b64_tr_b16 v[32:33], v24 offset:14336
    ds_read_b64_tr_b16 v[34:35], v24 offset:14848
    ds_read_b64_tr_b16 v[36:37], v25 offset:14336
    ds_read_b64_tr_b16 v[38:39], v25 offset:14848
    ds_read_b64_tr_b16 v[40:41], v26 offset:14336
    ds_read_b64_tr_b16 v[42:43], v26 offset:14848
    ds_read_b64_tr_b16 v[44:45], v27 offset:14336
    ds_read_b64_tr_b16 v[46:47], v27 offset:14848
    ds_read_b64_tr_b16 v[48:49], v24 offset:47104
    ds_read_b64_tr_b16 v[50:51], v24 offset:47616
    ds_read_b64_tr_b16 v[52:53], v25 offset:47104
    ds_read_b64_tr_b16 v[54:55], v25 offset:47616
    ds_read_b64_tr_b16 v[56:57], v26 offset:47104
    ds_read_b64_tr_b16 v[58:59], v26 offset:47616
    ds_read_b64_tr_b16 v[60:61], v27 offset:47104
    ds_read_b64_tr_b16 v[62:63], v27 offset:47616
    s_cmp_eq_u32 s44, 7
    s_cbranch_scc0 L_mjoin
    s_setprio 3
    s_and_b32 s45, s3, 1
    s_lshl_b32 s45, s45, 12
    s_add_u32 s50, s45, 131072
    s_lshl_b32 s45, s3, 4
    s_add_u32 s49, s50, s45
    v_mov_b32 v6, 0
    s_mov_b32 s75, 0
L_pollC0:
    buffer_load_dwordx4 v[8:11], v6, s[8:11], s49 offen sc0 sc1
    s_waitcnt vmcnt(0)
    v_cmp_ne_u32 vcc, s68, v11
    s_nop 4
    s_cbranch_vccz L_pollC0_done
    s_add_u32 s75, s75, 1
    s_cmp_gt_u32 s75, 20000
    s_cbranch_scc1 L_pollC0_done
    s_sleep 6
    s_branch L_pollC0
L_pollC0_done:
    s_mov_b32 s75, 0
L_pollC:
    buffer_load_dwordx4 v[8:11], v2, s[8:11], s50 offen offset:0 sc0 sc1
    buffer_load_dwordx4 v[12:15], v2, s[8:11], s50 offen offset:1024 sc0 sc1
    buffer_load_dwordx4 v[16:19], v2, s[8:11], s50 offen offset:2048 sc0 sc1
    buffer_load_dwordx4 v[20:23], v2, s[8:11], s50 offen offset:3072 sc0 sc1
    s_waitcnt vmcnt(0)
    v_xor_b32 v64, s68, v11
    v_xor_b32 v65, s68, v15
    v_xor_b32 v66, s68, v19
    v_xor_b32 v67, s68, v23
    v_or_b32 v64, v64, v65
    v_or_b32 v66, v66, v67
    v_or_b32 v64, v64, v66
    v_cmp_ne_u32 vcc, 0, v64
    s_nop 4
    s_cbranch_vccz L_pollC_done
    s_add_u32 s75, s75, 1
    s_cmp_gt_u32 s75, 20000
    s_cbranch_scc1 L_pollC_done
    s_sleep 4
    s_branch L_pollC
L_pollC_done:
    v_max3_u32 v64, v8, v12, v16
    v_max_u32 v64, v64, v20
    s_nop 1
    v_max_u32_dpp v64, v64, v64 row_shr:1 row_mask:0xf bank_mask:0xf
    s_nop 1
    v_max_u32_dpp v64, v64, v64 row_shr:2 row_mask:0xf bank_mask:0xf
    s_nop 1
    v_max_u32_dpp v64, v64, v64 row_shr:4 row_mask:0xf bank_mask:0xf
    s_nop 1
    v_max_u32_dpp v64, v64, v64 row_shr:8 row_mask:0xf bank_mask:0xf
    s_nop 1
    v_max_u32_dpp v64, v64, v64 row_bcast:15 row_mask:0xa bank_mask:0xf
    s_nop 1
    v_max_u32_dpp v64, v64, v64 row_bcast:31 row_mask:0xc bank_mask:0xf
    s_nop 0
    v_readlane_b32 s80, v64, 63
    s_nop 1
    v_cmp_eq_u32 vcc, s80, v12
    s_nop 1
    v_cndmask_b32 v9, v9, v13, vcc
    v_cndmask_b32 v10, v10, v14, vcc
    v_cndmask_b32 v8, v8, v12, vcc
    v_cmp_eq_u32 vcc, s80, v16
    s_nop 1
    v_cndmask_b32 v9, v9, v17, vcc
    v_cndmask_b32 v10, v10, v18, vcc
    v_cndmask_b32 v8, v8, v16, vcc
    v_cmp_eq_u32 vcc, s80, v20
    s_nop 1
    v_cndmask_b32 v9, v9, v21, vcc
    v_cndmask_b32 v10, v10, v22, vcc
    v_cndmask_b32 v8, v8, v20, vcc
    v_cmp_eq_u32 vcc, s80, v8
    s_ff1_i32_b64 s47, vcc
    v_readlane_b32 s45, v9, s47
    v_readlane_b32 s46, v10, s47
    v_mov_b32 v8, s80
    v_mov_b32 v9, s45
    v_mov_b32 v10, s46
    v_mov_b32 v11, s68
    v_mov_b32 v6, 13312
    s_mov_b64 exec, 1
    ds_write_b128 v6, v[8:11]
    s_mov_b64 exec, -1
    s_cmp_ge_u32 s3, 8
    s_cbranch_scc1 L_mjoin
    s_lshl_b32 s45, s3, 7
    s_add_u32 s45, s45, 4096
    v_lshlrev_b32 v6, 4, v1
    s_mov_b64 exec, 0xff
    buffer_store_dwordx4 v[8:11], v6, s[8:11], s45 offen sc0 sc1
    s_mov_b64 exec, -1
L_mjoin:
    s_waitcnt lgkmcnt(0)
    s_barrier
    s_setprio 1
    v_mov_b32 v6, 13312
    ds_read_b128 v[8:11], v6
    s_lshl_b32 s46, s58, 9
    s_lshl_b32 s47, s44, 6
    s_add_u32 s46, s46, s47
    s_waitcnt lgkmcnt(0)
    v_readfirstlane_b32 s80, v8
    v_readfirstlane_b32 s54, v9
    v_readfirstlane_b32 s55, v10
    s_and_b32 s45, s80, 0x7ff
    s_sub_u32 s45, 2047, s45
    s_lshl_b32 s45, s45, 11
    s_add_u32 s45, s45, s46
    buffer_load_dwordx4 v[8:11], v28, s[4:7], s45 offen
    v_mov_b32 v30, s54
    v_mov_b32 v31, s55
    v_mov_b32 v96, 0xffff0000
    s_lshl_b32 s45, s60, 8
    s_lshl_b32 s46, s44, 5
    s_add_u32 s45, s45, s46
    s_lshl_b32 s45, s45, 11
    s_lshl_b32 s46, s61, 7
    s_add_u32 s45, s45, s46
    v_lshrrev_b32 v6, 3, v1
    v_lshlrev_b32 v6, 11, v6
    v_and_b32 v7, 7, v1
    v_lshl_add_u32 v6, v7, 4, v6
    s_add_u32 s46, s45, 0
    buffer_load_dwordx4 v[100:103], v6, s[40:43], s46 offen
    s_add_u32 s46, s45, 16384
    buffer_load_dwordx4 v[104:107], v6, s[40:43], s46 offen
    s_add_u32 s46, s45, 32768
    buffer_load_dwordx4 v[108:111], v6, s[40:43], s46 offen
    s_add_u32 s46, s45, 49152
    buffer_load_dwordx4 v[112:115], v6, s[40:43], s46 offen
    s_waitcnt vmcnt(4)
    v_lshlrev_b32 v12, 16, v8
    v_and_b32 v13, v96, v8
    v_lshlrev_b32 v14, 16, v9
    v_and_b32 v15, v96, v9
    v_lshlrev_b32 v16, 16, v10
    v_and_b32 v17, v96, v10
    v_lshlrev_b32 v18, 16, v11
    v_and_b32 v19, v96, v11
    v_sub_f32 v12, v12, v30
    v_sub_f32 v13, v13, v30
    v_sub_f32 v14, v14, v30
    v_sub_f32 v15, v15, v30
    v_sub_f32 v16, v16, v30
    v_sub_f32 v17, v17, v30
    v_sub_f32 v18, v18, v30
    v_sub_f32 v19, v19, v30
    v_cvt_pk_bf16_f32 v8, v12, v13
    v_cvt_pk_bf16_f32 v9, v14, v15
    v_cvt_pk_bf16_f32 v10, v16, v17
    v_cvt_pk_bf16_f32 v11, v18, v19
    v_lshlrev_b32 v12, 16, v8
    v_and_b32 v13, v96, v8
    v_lshlrev_b32 v14, 16, v9
    v_and_b32 v15, v96, v9
    v_lshlrev_b32 v16, 16, v10
    v_and_b32 v17, v96, v10
    v_lshlrev_b32 v18, 16, v11
    v_and_b32 v19, v96, v11
    v_mul_f32 v12, v12, v31
    v_mul_f32 v13, v13, v31
    v_mul_f32 v14, v14, v31
    v_mul_f32 v15, v15, v31
    v_mul_f32 v16, v16, v31
    v_mul_f32 v17, v17, v31
    v_mul_f32 v18, v18, v31
    v_mul_f32 v19, v19, v31
    v_cvt_pk_bf16_f32 v20, v12, v13
    v_cvt_pk_bf16_f32 v21, v14, v15
    v_cvt_pk_bf16_f32 v22, v16, v17
    v_cvt_pk_bf16_f32 v23, v18, v19
    s_nop 1
    v_mfma_f32_16x16x32_bf16 v[64:67], v[20:23], v[32:35], 0
    v_mfma_f32_16x16x32_bf16 v[68:71], v[20:23], v[36:39], 0
    v_mfma_f32_16x16x32_bf16 v[72:75], v[20:23], v[40:43], 0
    v_mfma_f32_16x16x32_bf16 v[76:79], v[20:23], v[44:47], 0
    v_mfma_f32_16x16x32_bf16 v[80:83], v[20:23], v[48:51], 0
    v_mfma_f32_16x16x32_bf16 v[84:87], v[20:23], v[52:55], 0
    v_mfma_f32_16x16x32_bf16 v[88:91], v[20:23], v[56:59], 0
    v_mfma_f32_16x16x32_bf16 v[92:95], v[20:23], v[60:63], 0
    s_mov_b64 exec, 0xffff
    ds_write_b32 v29, v64 offset:0
    ds_write_b32 v29, v68 offset:64
    ds_write_b32 v29, v72 offset:128
    ds_write_b32 v29, v76 offset:192
    ds_write_b32 v29, v80 offset:256
    ds_write_b32 v29, v84 offset:320
    ds_write_b32 v29, v88 offset:384
    ds_write_b32 v29, v92 offset:448
    s_mov_b64 exec, -1
    s_waitcnt lgkmcnt(0)
    s_barrier
    s_cmp_ge_u32 s44, 2
    s_cbranch_scc1 L_mnopart
    v_lshlrev_b32 v6, 2, v1
    s_lshl_b32 s45, s44, 8
    v_add_u32 v7, s45, v6
    ds_read_b32 v8, v7 offset:0
    ds_read_b32 v9, v7 offset:512
    ds_read_b32 v10, v7 offset:1024
    ds_read_b32 v11, v7 offset:1536
    ds_read_b32 v12, v7 offset:2048
    ds_read_b32 v13, v7 offset:2560
    ds_read_b32 v14, v7 offset:3072
    ds_read_b32 v15, v7 offset:3584
    s_lshl_b32 s45, s58, 1
    s_add_u32 s45, s45, s44
    s_mul_i32 s45, s45, 14336
    s_lshl_b32 s46, s59, 8
    s_add_u32 s45, s45, s46
    s_add_u32 s45, s45, 11862016
    v_mov_b32 v16, 0xff
    s_waitcnt lgkmcnt(0)
    v_add_f32 v8, v8, v9
    v_add_f32 v10, v10, v11
    v_add_f32 v12, v12, v13
    v_add_f32 v14, v14, v15
    v_add_f32 v8, v8, v10
    v_add_f32 v12, v12, v14
    v_add_f32 v8, v8, v12
    v_bfi_b32 v8, v16, s69, v8
    buffer_store_dword v8, v6, s[8:11], s45 offen sc0 sc1
L_mnopart:
    s_waitcnt vmcnt(0)
    v_lshlrev_b32 v64, 16, v100
    v_and_b32 v65, v96, v100
    v_lshlrev_b32 v66, 16, v101
    v_and_b32 v67, v96, v101
    v_lshlrev_b32 v68, 16, v102
    v_and_b32 v69, v96, v102
    v_lshlrev_b32 v70, 16, v103
    v_and_b32 v71, v96, v103
    v_lshlrev_b32 v72, 16, v104
    v_and_b32 v73, v96, v104
    v_lshlrev_b32 v74, 16, v105
    v_and_b32 v75, v96, v105
    v_lshlrev_b32 v76, 16, v106
    v_and_b32 v77, v96, v106
    v_lshlrev_b32 v78, 16, v107
    v_and_b32 v79, v96, v107
    v_lshlrev_b32 v80, 16, v108
    v_and_b32 v81, v96, v108
    v_lshlrev_b32 v82, 16, v109
    v_and_b32 v83, v96, v109
    v_lshlrev_b32 v84, 16, v110
    v_and_b32 v85, v96, v110
    v_lshlrev_b32 v86, 16, v111
    v_and_b32 v87, v96, v111
    v_lshlrev_b32 v88, 16, v112
    v_and_b32 v89, v96, v112
    v_lshlrev_b32 v90, 16, v113
    v_and_b32 v91, v96, v113
    v_lshlrev_b32 v92, 16, v114
    v_and_b32 v93, v96, v114
    v_lshlrev_b32 v94, 16, v115
    v_and_b32 v95, v96, v115
    v_lshrrev_b32 v6, 3, v1
    v_mul_u32_u24 v6, 14336, v6
    v_and_b32 v7, 7, v1
    v_lshl_add_u32 v6, v7, 4, v6
    s_lshl_b32 s50, s60, 10
    s_lshl_b32 s46, s44, 7
    s_add_u32 s50, s50, s46
    s_add_u32 s50, s50, 11862016
    v_mov_b32 v16, 0xff
    v_lshlrev_b32 v24, 4, v7
    s_lshl_b32 s46, s44, 7
    s_add_u32 s46, s46, 12288
    v_add_u32 v24, s46, v24
    v_lshrrev_b32 v25, 3, v1
    v_lshlrev_b32 v25, 2, v25
    v_add_u32 v25, s46, v25
    v_and_b32 v26, 7, v1
    v_lshlrev_b32 v26, 5, v26
    v_lshrrev_b32 v27, 4, v1
    v_lshl_add_u32 v26, v27, 3, v26
    s_lshl_b32 s46, s44, 8
    s_add_u32 s46, s46, 4096
    v_add_u32 v26, s46, v26
    v_mov_b32 v27, 0xbfb8aa3b
    s_mov_b32 s75, 0
L_pollP:
    buffer_load_dwordx4 v[8:11], v6, s[8:11], s50 offen sc0 sc1
    s_waitcnt vmcnt(0)
    v_xor_b32 v8, s69, v8
    v_xor_b32 v9, s69, v9
    v_xor_b32 v10, s69, v10
    v_xor_b32 v11, s69, v11
    v_or_b32 v12, v8, v9
    v_or_b32 v14, v10, v11
    v_or_b32 v12, v12, v14
    v_and_b32 v12, v16, v12
    v_cmp_ne_u32 vcc, 0, v12
    s_nop 4
    s_cbranch_vccz L_pollP_done
    s_add_u32 s75, s75, 1
    s_cmp_gt_u32 s75, 20000
    s_cbranch_scc1 L_pollP_done
    s_sleep 4
    s_branch L_pollP
L_pollP_done:
    v_mov_b32 v12, v8
    v_mov_b32 v13, v9
    v_mov_b32 v14, v10
    v_mov_b32 v15, v11
    v_permlane32_swap_b32 v8, v12
    v_permlane32_swap_b32 v9, v13
    v_permlane32_swap_b32 v10, v14
    v_permlane32_swap_b32 v11, v15
    v_add_f32 v8, v8, v12
    v_add_f32 v9, v9, v13
    v_add_f32 v10, v10, v14
    v_add_f32 v11, v11, v15
    v_mov_b32 v12, v8
    v_mov_b32 v13, v9
    v_mov_b32 v14, v10
    v_mov_b32 v15, v11
    v_permlane16_swap_b32 v8, v12
    v_permlane16_swap_b32 v9, v13
    v_permlane16_swap_b32 v10, v14
    v_permlane16_swap_b32 v11, v15
    v_add_f32 v8, v8, v12
    v_add_f32 v9, v9, v13
    v_add_f32 v10, v10, v14
    v_add_f32 v11, v11, v15
    v_mov_b32_dpp v12, v8 row_ror:8 row_mask:0xf bank_mask:0xf
    v_mov_b32_dpp v13, v9 row_ror:8 row_mask:0xf bank_mask:0xf
    v_mov_b32_dpp v14, v10 row_ror:8 row_mask:0xf bank_mask:0xf
    v_mov_b32_dpp v15, v11 row_ror:8 row_mask:0xf bank_mask:0xf
    v_cvt_pk_bf16_f32 v16, v8, v9
    v_cvt_pk_bf16_f32 v18, v12, v13
    v_cvt_pk_bf16_f32 v17, v10, v11
    v_cvt_pk_bf16_f32 v19, v14, v15
    v_lshlrev_b32 v8, 16, v16
    v_and_b32 v9, v96, v16
    v_lshlrev_b32 v12, 16, v18
    v_and_b32 v13, v96, v18
    v_lshlrev_b32 v10, 16, v17
    v_and_b32 v11, v96, v17
    v_lshlrev_b32 v14, 16, v19
    v_and_b32 v15, v96, v19
    v_mul_f32 v16, v27, v8
    v_mul_f32 v17, v27, v9
    v_mul_f32 v18, v27, v10
    v_mul_f32 v19, v27, v11
    v_exp_f32 v16, v16
    v_exp_f32 v17, v17
    v_exp_f32 v18, v18
    v_exp_f32 v19, v19
    v_add_f32 v16, 1.0, v16
    v_add_f32 v17, 1.0, v17
    v_add_f32 v18, 1.0, v18
    v_add_f32 v19, 1.0, v19
    v_rcp_f32 v16, v16
    v_rcp_f32 v17, v17
    v_rcp_f32 v18, v18
    v_rcp_f32 v19, v19
    v_mul_f32 v8, v8, v16
    v_mul_f32 v9, v9, v17
    v_mul_f32 v10, v10, v18
    v_mul_f32 v11, v11, v19
    v_cvt_pk_bf16_f32 v16, v8, v9
    v_cvt_pk_bf16_f32 v17, v10, v11
    v_lshlrev_b32 v8, 16, v16
    v_and_b32 v9, v96, v16
    v_lshlrev_b32 v10, 16, v17
    v_and_b32 v11, v96, v17
    v_mul_f32 v8, v8, v12
    v_mul_f32 v9, v9, v13
    v_mul_f32 v10, v10, v14
    v_mul_f32 v11, v11, v15
    v_cvt_pk_bf16_f32 v16, v8, v9
    v_cvt_pk_bf16_f32 v17, v10, v11
    v_lshlrev_b32 v8, 16, v16
    v_and_b32 v9, v96, v16
    v_lshlrev_b32 v10, 16, v17
    v_and_b32 v11, v96, v17
    s_mov_b64 exec, 0xff
    ds_write_b128 v24, v[8:11]
    s_mov_b64 exec, -1
    s_waitcnt lgkmcnt(0)
    ds_read_b32 v20, v25 offset:0
    ds_read_b32 v21, v25 offset:32
    ds_read_b32 v22, v25 offset:64
    ds_read_b32 v23, v25 offset:96
    s_waitcnt lgkmcnt(0)
    v_mul_f32 v32, v20, v64
    v_mul_f32 v33, v20, v65
    v_mul_f32 v34, v20, v66
    v_mul_f32 v35, v20, v67
    v_mul_f32 v36, v20, v68
    v_mul_f32 v37, v20, v69
    v_mul_f32 v38, v20, v70
    v_mul_f32 v39, v20, v71
    v_fmac_f32 v32, v21, v72
    v_fmac_f32 v33, v21, v73
    v_fmac_f32 v34, v21, v74
    v_fmac_f32 v35, v21, v75
    v_fmac_f32 v36, v21, v76
    v_fmac_f32 v37, v21, v77
    v_fmac_f32 v38, v21, v78
    v_fmac_f32 v39, v21, v79
    v_fmac_f32 v32, v22, v80
    v_fmac_f32 v33, v22, v81
    v_fmac_f32 v34, v22, v82
    v_fmac_f32 v35, v22, v83
    v_fmac_f32 v36, v22, v84
    v_fmac_f32 v37, v22, v85
    v_fmac_f32 v38, v22, v86
    v_fmac_f32 v39, v22, v87
    v_fmac_f32 v32, v23, v88
    v_fmac_f32 v33, v23, v89
    v_fmac_f32 v34, v23, v90
    v_fmac_f32 v35, v23, v91
    v_fmac_f32 v36, v23, v92
    v_fmac_f32 v37, v23, v93
    v_fmac_f32 v38, v23, v94
    v_fmac_f32 v39, v23, v95
    v_permlane32_swap_b32 v32, v36
    v_permlane32_swap_b32 v33, v37
    v_permlane32_swap_b32 v34, v38
    v_permlane32_swap_b32 v35, v39
    v_add_f32 v32, v32, v36
    v_add_f32 v33, v33, v37
    v_add_f32 v34, v34, v38
    v_add_f32 v35, v35, v39
    s_nop 0
    v_permlane16_swap_b32 v32, v34
    v_permlane16_swap_b32 v33, v35
    v_add_f32 v32, v32, v34
    v_add_f32 v33, v33, v35
    s_nop 0
    v_add_f32_dpp v32, v32, v32 row_ror:8 row_mask:0xf bank_mask:0xf
    v_add_f32_dpp v33, v33, v33 row_ror:8 row_mask:0xf bank_mask:0xf
    ds_write_b64 v26, v[32:33]
    s_waitcnt lgkmcnt(0)
    s_barrier
    s_cmp_lg_u32 s44, 0
    s_cbranch_scc1 L_mend
    v_lshlrev_b32 v6, 2, v1
    ds_read_b32 v8, v6 offset:4096
    ds_read_b32 v9, v6 offset:4352
    ds_read_b32 v10, v6 offset:4608
    ds_read_b32 v11, v6 offset:4864
    ds_read_b32 v12, v6 offset:5120
    ds_read_b32 v13, v6 offset:5376
    ds_read_b32 v14, v6 offset:5632
    ds_read_b32 v15, v6 offset:5888
    s_lshl_b32 s45, s60, 12
    s_lshl_b32 s46, s61, 8
    s_add_u32 s45, s45, s46
    s_add_u32 s45, s45, 11730944
    v_mov_b32 v16, 0xff
    s_waitcnt lgkmcnt(0)
    v_add_f32 v8, v8, v9
    v_add_f32 v10, v10, v11
    v_add_f32 v12, v12, v13
    v_add_f32 v14, v14, v15
    v_add_f32 v8, v8, v10
    v_add_f32 v12, v12, v14
    v_add_f32 v8, v8, v12
    v_bfi_b32 v8, v16, s69, v8
    buffer_store_dword v8, v6, s[8:11], s45 offen sc0 sc1
L_mend:
    s_branch L_fin
L_spare:
    s_branch L_nyqtask
L_pfonly:
    s_waitcnt vmcnt(0)
    s_branch L_fin
L_nyqtask:
    s_cmp_lg_u32 s44, 0
    s_cbranch_scc1 L_fin
    s_and_b32 s58, s2, 7
    s_waitcnt lgkmcnt(0)
    s_add_u32 s68, s68, 1
    s_lshl_b32 s62, s58, 11
    s_sub_u32 s45, s2, 256
    s_lshl_b32 s45, s45, 3
    s_add_u32 s50, s62, s45
    s_add_u32 s50, s50, 65536
    v_mov_b32 v6, 0
    s_mov_b32 s75, 0
L_pollN0:
    buffer_load_dwordx2 v[8:9], v6, s[8:11], s50 offen sc0 sc1
    s_waitcnt vmcnt(0)
    v_cmp_ne_u32 vcc, s68, v9
    s_nop 4
    s_cbranch_vccz L_pollN0_done
    s_add_u32 s75, s75, 1
    s_cmp_gt_u32 s75, 20000
    s_cbranch_scc1 L_pollN0_done
    s_sleep 8
    s_branch L_pollN0
L_pollN0_done:
    s_mov_b32 s45, 0
    buffer_load_dwordx4 v[8:11], v2, s[12:15], s45 offen
    s_mov_b32 s45, 1024
    buffer_load_dwordx4 v[12:15], v2, s[12:15], s45 offen
    s_mov_b32 s45, 2048
    buffer_load_dwordx4 v[16:19], v2, s[12:15], s45 offen
    s_mov_b32 s45, 3072
    buffer_load_dwordx4 v[20:23], v2, s[12:15], s45 offen
    s_mov_b32 s45, 4096
    buffer_load_dwordx4 v[24:27], v2, s[12:15], s45 offen
    s_mov_b32 s45, 5120
    buffer_load_dwordx4 v[28:31], v2, s[12:15], s45 offen
    s_mov_b32 s45, 6144
    buffer_load_dwordx4 v[32:35], v2, s[12:15], s45 offen
    s_mov_b32 s45, 7168
    buffer_load_dwordx4 v[36:39], v2, s[12:15], s45 offen
    s_mov_b32 s45, 8192
    buffer_load_dwordx4 v[40:43], v2, s[12:15], s45 offen
    s_mov_b32 s45, 9216
    buffer_load_dwordx4 v[44:47], v2, s[12:15], s45 offen
    s_mov_b32 s45, 10240
    buffer_load_dwordx4 v[48:51], v2, s[12:15], s45 offen
    v_and_b32 v6, 15, v1
    v_lshrrev_b32 v7, 4, v1
    v_lshl_add_u32 v6, v7, 6, v6
    v_mul_u32_u24 v3, 8208, v6
    s_mul_i32 s61, s58, 1026
    s_add_u32 s61, s61, 1024
    s_add_u32 s45, s61, 0
    buffer_load_ushort v52, v3, s[20:23], s45 offen
    buffer_load_ushort v53, v3, s[24:27], s45 offen
    s_add_u32 s45, s61, 131328
    buffer_load_ushort v56, v3, s[20:23], s45 offen
    buffer_load_ushort v57, v3, s[24:27], s45 offen
    s_add_u32 s45, s61, 262656
    buffer_load_ushort v60, v3, s[20:23], s45 offen
    buffer_load_ushort v61, v3, s[24:27], s45 offen
    s_add_u32 s45, s61, 393984
    buffer_load_ushort v64, v3, s[20:23], s45 offen
    buffer_load_ushort v65, v3, s[24:27], s45 offen
    v_lshlrev_b32 v4, 3, v6
    s_lshl_b32 s62, s58, 11
    s_add_u32 s63, s62, 98304
    s_add_u32 s62, s62, 65536
    s_waitcnt vmcnt(0)
    v_lshlrev_b32 v52, 16, v52
    v_lshlrev_b32 v53, 16, v53
    v_lshlrev_b32 v56, 16, v56
    v_lshlrev_b32 v57, 16, v57
    v_lshlrev_b32 v60, 16, v60
    v_lshlrev_b32 v61, 16, v61
    v_lshlrev_b32 v64, 16, v64
    v_lshlrev_b32 v65, 16, v65
    s_mov_b32 s75, 0
L_pollN:
    buffer_load_dwordx2 v[84:85], v4, s[8:11], s62 offen offset:0 sc0 sc1
    buffer_load_dwordx2 v[86:87], v4, s[8:11], s62 offen offset:128 sc0 sc1
    buffer_load_dwordx2 v[88:89], v4, s[8:11], s62 offen offset:256 sc0 sc1
    buffer_load_dwordx2 v[90:91], v4, s[8:11], s62 offen offset:384 sc0 sc1
    s_waitcnt vmcnt(0)
    v_xor_b32 v100, s68, v85
    v_xor_b32 v101, s68, v87
    v_xor_b32 v102, s68, v89
    v_xor_b32 v103, s68, v91
    v_or_b32 v100, v100, v101
    v_or_b32 v102, v102, v103
    v_or_b32 v100, v100, v102
    v_cmp_ne_u32 vcc, 0, v100
    s_nop 4
    s_cbranch_vccz L_pollN_done
    s_add_u32 s75, s75, 1
    s_cmp_gt_u32 s75, 20000
    s_cbranch_scc1 L_pollN_done
    s_sleep 4
    s_branch L_pollN
L_pollN_done:
    v_mov_b32 v68, v84
    v_mov_b32 v69, v86
    v_mov_b32 v70, v88
    v_mov_b32 v71, v90
    s_nop 1
    v_mfma_f32_16x16x32_f16 v[84:87], v[68:71], v[8:11], 0
    v_mfma_f32_16x16x32_f16 v[88:91], v[68:71], v[12:15], 0
    s_nop 7
    v_cvt_pk_f16_f32 v100, v84, v88
    v_cvt_pk_f16_f32 v101, v85, v89
    v_cvt_pk_f16_f32 v102, v86, v90
    v_cvt_pk_f16_f32 v103, v87, v91
    v_pk_mul_f16 v84, v100, v16 op_sel:[0,0] op_sel_hi:[0,1]
    v_pk_mul_f16 v85, v101, v17 op_sel:[0,0] op_sel_hi:[0,1]
    v_pk_mul_f16 v86, v102, v18 op_sel:[0,0] op_sel_hi:[0,1]
    v_pk_mul_f16 v87, v103, v19 op_sel:[0,0] op_sel_hi:[0,1]
    v_pk_fma_f16 v100, v100, v16, v84 op_sel:[1,1,0] op_sel_hi:[1,0,1] neg_lo:[0,1,0]
    v_pk_fma_f16 v101, v101, v17, v85 op_sel:[1,1,0] op_sel_hi:[1,0,1] neg_lo:[0,1,0]
    v_pk_fma_f16 v102, v102, v18, v86 op_sel:[1,1,0] op_sel_hi:[1,0,1] neg_lo:[0,1,0]
    v_pk_fma_f16 v103, v103, v19, v87 op_sel:[1,1,0] op_sel_hi:[1,0,1] neg_lo:[0,1,0]
    s_nop 1
    v_mfma_f32_16x16x32_f16 v[84:87], v[20:23], v[100:103], 0
    v_mfma_f32_16x16x32_f16 v[88:91], v[24:27], v[100:103], 0
    s_nop 6
    v_mul_f32 v108, v84, v52
    v_mul_f32 v109, v84, v53
    v_fma_f32 v108, -v85, v53, v108
    v_fmac_f32 v109, v85, v52
    v_mul_f32 v110, v86, v56
    v_mul_f32 v111, v86, v57
    v_fma_f32 v110, -v87, v57, v110
    v_fmac_f32 v111, v87, v56
    v_mul_f32 v112, v88, v60
    v_mul_f32 v113, v88, v61
    v_fma_f32 v112, -v89, v61, v112
    v_fmac_f32 v113, v89, v60
    v_mul_f32 v114, v90, v64
    v_mul_f32 v115, v90, v65
    v_fma_f32 v114, -v91, v65, v114
    v_fmac_f32 v115, v91, v64
    v_cvt_pk_bf16_f32 v100, v108, v109
    v_cvt_pk_bf16_f32 v101, v110, v111
    v_cvt_pk_bf16_f32 v102, v112, v113
    v_cvt_pk_bf16_f32 v103, v114, v115
    s_nop 1
    v_mfma_f32_16x16x32_bf16 v[72:75], v[100:103], v[28:31], 0
    v_mfma_f32_16x16x32_bf16 v[76:79], v[100:103], v[32:35], 0
    s_nop 6
    v_mul_f32 v108, v72, v36
    v_mul_f32 v109, v72, v37
    v_fma_f32 v108, -v76, v37, v108
    v_fmac_f32 v109, v76, v36
    v_mul_f32 v110, v73, v38
    v_mul_f32 v111, v73, v39
    v_fma_f32 v110, -v77, v39, v110
    v_fmac_f32 v111, v77, v38
    v_mul_f32 v112, v74, v40
    v_mul_f32 v113, v74, v41
    v_fma_f32 v112, -v78, v41, v112
    v_fmac_f32 v113, v78, v40
    v_mul_f32 v114, v75, v42
    v_mul_f32 v115, v75, v43
    v_fma_f32 v114, -v79, v43, v114
    v_fmac_f32 v115, v79, v42
    v_cvt_pk_bf16_f32 v100, v108, v109
    v_cvt_pk_bf16_f32 v101, v110, v111
    v_cvt_pk_bf16_f32 v102, v112, v113
    v_cvt_pk_bf16_f32 v103, v114, v115
    s_nop 1
    v_mfma_f32_16x16x32_bf16 v[84:87], v[44:47], v[100:103], 0
    v_mfma_f32_16x16x32_bf16 v[88:91], v[48:51], v[100:103], 0
    s_nop 6
    v_cvt_pk_bf16_f32 v108, v84, v85
    v_mov_b32 v109, s68
    buffer_store_dwordx2 v[108:109], v4, s[8:11], s63 offen offset:0 sc0 sc1
    v_cvt_pk_bf16_f32 v110, v86, v87
    v_mov_b32 v111, s68
    buffer_store_dwordx2 v[110:111], v4, s[8:11], s63 offen offset:128 sc0 sc1
    v_cvt_pk_bf16_f32 v112, v88, v89
    v_mov_b32 v113, s68
    buffer_store_dwordx2 v[112:113], v4, s[8:11], s63 offen offset:256 sc0 sc1
    v_cvt_pk_bf16_f32 v114, v90, v91
    v_mov_b32 v115, s68
    buffer_store_dwordx2 v[114:115], v4, s[8:11], s63 offen offset:384 sc0 sc1
    s_branch L_fin
L_fin:
recurrent_scan__spectral_gfnet__moe_arch_mod__prompt_kernel_end:
    s_endpgm
.p2align 8
fft_tables:
    .long 0x3c00,0x3c00,0x3c00,0x3c00,0x3c00,0x361f3b64,0x39a839a8,0x3b64361f
    .long 0x3c00,0x39a839a8,0x3c000000,0x39a8b9a8,0x3c00,0x3b64361f,0x39a8b9a8,0xb61fbb64
    .long 0x3c00,0x3c000000,0xbc00,0xbc008000,0x3c00,0x3b64b61f,0xb9a8b9a8,0xb61f3b64
    .long 0x3c00,0x39a8b9a8,0xbc008000,0x39a839a8,0x3c00,0x361fbb64,0xb9a839a8,0x3b64b61f
    .long 0x3c00,0xbc00,0x3c00,0xbc00,0x3c00,0xb61fbb64,0x39a839a8,0xbb64b61f
    .long 0x3c00,0xb9a8b9a8,0x3c000000,0xb9a839a8,0x3c00,0xbb64b61f,0x39a8b9a8,0x361f3b64
    .long 0x3c00,0xbc008000,0xbc00,0x3c000000,0x3c00,0xbb64361f,0xb9a8b9a8,0x361fbb64
    .long 0x3c00,0xb9a839a8,0xbc008000,0xb9a8b9a8,0x3c00,0xb61f3b64,0xb9a839a8,0xbb64361f
    .long 0x3c00,0x3c00,0x3c00,0x3c00,0x3c000000,0x3b64b61f,0x39a8b9a8,0x361fbb64
    .long 0xbc00,0xb9a8b9a8,0xbc008000,0xb9a839a8,0xbc008000,0xb61f3b64,0x39a839a8,0x3b64b61f
    .long 0x3c00,0x3c000000,0xbc00,0xbc008000,0x3c000000,0xb61fbb64,0xb9a839a8,0x3b64361f
    .long 0xbc00,0xb9a839a8,0x3c000000,0xb9a8b9a8,0xbc008000,0x3b64361f,0xb9a8b9a8,0x361f3b64
    .long 0x3c00,0xbc00,0x3c00,0xbc00,0x3c000000,0xbb64361f,0x39a8b9a8,0xb61f3b64
    .long 0xbc00,0x39a839a8,0xbc008000,0x39a8b9a8,0xbc008000,0x361fbb64,0x39a839a8,0xbb64361f
    .long 0x3c00,0xbc008000,0xbc00,0x3c000000,0x3c000000,0x361f3b64,0xb9a839a8,0xbb64b61f
    .long 0xbc00,0x39a8b9a8,0x3c000000,0x39a839a8,0xbc008000,0xbb64b61f,0xb9a8b9a8,0xb61fbb64
    .long 0x3c00,0x3c00,0x3c00,0x3c00,0xbc00,0xb61fbb64,0xb9a8b9a8,0xbb64b61f
    .long 0x3c00,0x39a839a8,0x3c000000,0x39a8b9a8,0xbc00,0xbb64b61f,0xb9a839a8,0x361f3b64
    .long 0x3c00,0x3c000000,0xbc00,0xbc008000,0xbc00,0xbb64361f,0x39a839a8,0x361fbb64
    .long 0x3c00,0x39a8b9a8,0xbc008000,0x39a839a8,0xbc00,0xb61f3b64,0x39a8b9a8,0xbb64361f
    .long 0x3c00,0xbc00,0x3c00,0xbc00,0xbc00,0x361f3b64,0xb9a8b9a8,0x3b64361f
    .long 0x3c00,0xb9a8b9a8,0x3c000000,0xb9a839a8,0xbc00,0x3b64361f,0xb9a839a8,0xb61fbb64
    .long 0x3c00,0xbc008000,0xbc00,0x3c000000,0xbc00,0x3b64b61f,0x39a839a8,0xb61f3b64
    .long 0x3c00,0xb9a839a8,0xbc008000,0xb9a8b9a8,0xbc00,0x361fbb64,0x39a8b9a8,0x3b64b61f
    .long 0x3c00,0x3c00,0x3c00,0x3c00,0xbc008000,0xbb64361f,0xb9a839a8,0xb61f3b64
    .long 0xbc00,0xb9a8b9a8,0xbc008000,0xb9a839a8,0x3c000000,0x361fbb64,0xb9a8b9a8,0xbb64361f
    .long 0x3c00,0x3c000000,0xbc00,0xbc008000,0xbc008000,0x361f3b64,0x39a8b9a8,0xbb64b61f
    .long 0xbc00,0xb9a839a8,0x3c000000,0xb9a8b9a8,0x3c000000,0xbb64b61f,0x39a839a8,0xb61fbb64
    .long 0x3c00,0xbc00,0x3c00,0xbc00,0xbc008000,0x3b64b61f,0xb9a839a8,0x361fbb64
    .long 0xbc00,0x39a839a8,0xbc008000,0x39a8b9a8,0x3c000000,0xb61f3b64,0xb9a8b9a8,0x3b64b61f
    .long 0x3c00,0xbc008000,0xbc00,0x3c000000,0xbc008000,0xb61fbb64,0x39a8b9a8,0x3b64361f
    .long 0xbc00,0x39a8b9a8,0x3c000000,0x39a839a8,0x3c000000,0x3b64361f,0x39a839a8,0x361f3b64
    .long 0x3c008000,0x3c008000,0x3c008000,0x3c008000,0x3c008000,0x3b64b61f,0x39a8b9a8,0x361fbb64
    .long 0x3c008000,0x39a8b9a8,0xbc00,0xb9a8b9a8,0x3c008000,0x361fbb64,0xb9a8b9a8,0xbb64361f
    .long 0x3c008000,0xbc00,0xbc008000,0x80003c00,0x3c008000,0xb61fbb64,0xb9a839a8,0x3b64361f
    .long 0x3c008000,0xb9a8b9a8,0x80003c00,0x39a8b9a8,0x3c008000,0xbb64b61f,0x39a839a8,0xb61fbb64
    .long 0x3c008000,0xbc008000,0x3c008000,0xbc008000,0x3c008000,0xbb64361f,0x39a8b9a8,0xb61f3b64
    .long 0x3c008000,0xb9a839a8,0xbc00,0x39a839a8,0x3c008000,0xb61f3b64,0xb9a8b9a8,0x3b64b61f
    .long 0x3c008000,0x80003c00,0xbc008000,0xbc00,0x3c008000,0x361f3b64,0xb9a839a8,0xbb64b61f
    .long 0x3c008000,0x39a839a8,0x80003c00,0xb9a839a8,0x3c008000,0x3b64361f,0x39a839a8,0x361f3b64
    .long 0x3c008000,0x3c008000,0x3c008000,0x3c008000,0xbc00,0xb61fbb64,0xb9a8b9a8,0xbb64b61f
    .long 0xbc008000,0xb9a839a8,0x80003c00,0x39a839a8,0x80003c00,0x3b64361f,0x39a8b9a8,0xb61fbb64
    .long 0x3c008000,0xbc00,0xbc008000,0x80003c00,0xbc00,0xbb64361f,0x39a839a8,0x361fbb64
    .long 0xbc008000,0x39a839a8,0xbc00,0xb9a839a8,0x80003c00,0x361fbb64,0xb9a839a8,0x3b64b61f
    .long 0x3c008000,0xbc008000,0x3c008000,0xbc008000,0xbc00,0x361f3b64,0xb9a8b9a8,0x3b64361f
    .long 0xbc008000,0x39a8b9a8,0x80003c00,0xb9a8b9a8,0x80003c00,0xbb64b61f,0x39a8b9a8,0x361f3b64
    .long 0x3c008000,0x80003c00,0xbc008000,0xbc00,0xbc00,0x3b64b61f,0x39a839a8,0xb61f3b64
    .long 0xbc008000,0xb9a8b9a8,0xbc00,0x39a8b9a8,0x80003c00,0xb61f3b64,0xb9a839a8,0xbb64361f
    .long 0x3c008000,0x3c008000,0x3c008000,0x3c008000,0xbc008000,0xbb64361f,0xb9a839a8,0xb61f3b64
    .long 0x3c008000,0x39a8b9a8,0xbc00,0xb9a8b9a8,0xbc008000,0xb61f3b64,0x39a839a8,0x3b64b61f
    .long 0x3c008000,0xbc00,0xbc008000,0x80003c00,0xbc008000,0x361f3b64,0x39a8b9a8,0xbb64b61f
    .long 0x3c008000,0xb9a8b9a8,0x80003c00,0x39a8b9a8,0xbc008000,0x3b64361f,0xb9a8b9a8,0x361f3b64
    .long 0x3c008000,0xbc008000,0x3c008000,0xbc008000,0xbc008000,0x3b64b61f,0xb9a839a8,0x361fbb64
    .long 0x3c008000,0xb9a839a8,0xbc00,0x39a839a8,0xbc008000,0x361fbb64,0x39a839a8,0xbb64361f
    .long 0x3c008000,0x80003c00,0xbc008000,0xbc00,0xbc008000,0xb61fbb64,0x39a8b9a8,0x3b64361f
    .long 0x3c008000,0x39a839a8,0x80003c00,0xb9a839a8,0xbc008000,0xbb64b61f,0xb9a8b9a8,0xb61fbb64
    .long 0x3c008000,0x3c008000,0x3c008000,0x3c008000,0x80003c00,0x361f3b64,0x39a839a8,0x3b64361f
    .long 0xbc008000,0xb9a839a8,0x80003c00,0x39a839a8,0xbc00,0xbb64b61f,0xb9a839a8,0x361f3b64
    .long 0x3c008000,0xbc00,0xbc008000,0x80003c00,0x80003c00,0x3b64b61f,0xb9a8b9a8,0xb61f3b64
    .long 0xbc008000,0x39a839a8,0xbc00,0xb9a839a8,0xbc00,0xb61f3b64,0x39a8b9a8,0xbb64361f
    .long 0x3c008000,0xbc008000,0x3c008000,0xbc008000,0x80003c00,0xb61fbb64,0x39a839a8,0xbb64b61f
    .long 0xbc008000,0x39a8b9a8,0x80003c00,0xb9a8b9a8,0xbc00,0x3b64361f,0xb9a839a8,0xb61fbb64
    .long 0x3c008000,0x80003c00,0xbc008000,0xbc00,0x80003c00,0xbb64361f,0xb9a8b9a8,0x361fbb64
    .long 0xbc008000,0xb9a8b9a8,0xbc00,0x39a8b9a8,0xbc00,0x361fbb64,0x39a8b9a8,0x3b64b61f
    .long 0x80003c00,0x80003c00,0x80003c00,0x80003c00,0x80003c00,0xa6483bff,0xaa483bfe,0xacb53bfa
    .long 0x80003c00,0xaa483bfe,0xae463bf6,0xb0b23bea,0x80003c00,0xacb53bfa,0xb0b23bea,0xb3033bce
    .long 0x80003c00,0xae463bf6,0xb23e3bd9,0xb4a53ba8,0x80003c00,0xafd63bf1,0xb3c63bc3,0xb5c23b77
    .long 0x80003c00,0xb0b23bea,0xb4a53ba8,0xb6d73b3b,0x80003c00,0xb1793be2,0xb5643b88,0xb7e33af6
    .long 0x80003c00,0xb23e3bd9,0xb61f3b64,0xb8723aa7,0x80003c00,0xb3033bce,0xb6d73b3b,0xb8ec3a4f
    .long 0x80003c00,0xb3c63bc3,0xb78b3b0e,0xb95f39ed,0x80003c00,0xb4443bb6,0xb81d3add,0xb9cb3984
    .long 0x80003c00,0xb4a53ba8,0xb8723aa7,0xba2f3913,0x80003c00,0xb5053b99,0xb8c43a6d,0xba8a389b
    .long 0x80003c00,0xb5643b88,0xb9133a2f,0xbadd381d,0x80003c00,0xb5c23b77,0xb95f39ed,0xbb253732
    .long 0x80003c00,0x80003c00,0x80003c00,0x80003c00,0xae463bf6,0xafd63bf1,0xb0b23bea,0xb1793be2
    .long 0xb23e3bd9,0xb3c63bc3,0xb4a53ba8,0xb5643b88,0xb4a53ba8,0xb5c23b77,0xb6d73b3b,0xb7e33af6
    .long 0xb61f3b64,0xb78b3b0e,0xb8723aa7,0xb9133a2f,0xb78b3b0e,0xb89b3a8a,0xb95f39ed,0xba0f393a
    .long 0xb8723aa7,0xb95f39ed,0xba2f3913,0xbadd381d,0xb9133a2f,0xba0f393a,0xbadd381d,0xbb7735c2
    .long 0xb9a839a8,0xbaa73872,0xbb64361f,0xbbd9323e,0xba2f3913,0xbb253732,0xbbc333c6,0xbbff2648
    .long 0xbaa73872,0xbb883564,0xbbf62e46,0xbbeab0b2,0xbb0e378b,0xbbce3303,0xbbfeaa48,0xbb99b505
    .long 0xbb64361f,0xbbf62e46,0xbbd9b23e,0xbb0eb78b,0xbba834a5,0xbbffa648,0xbb88b564,0xba4fb8ec
    .long 0xbbd9323e,0xbbeab0b2,0xbb0eb78b,0xb95fb9ed,0xbbf62e46,0xbbb6b444,0xba6db8c4,0xb848bac2
    .long 0x80003c00,0x80003c00,0x80003c00,0x80003c00,0xb23e3bd9,0xb3033bce,0xb3c63bc3,0xb4443bb6
    .long 0xb61f3b64,0xb6d73b3b,0xb78b3b0e,0xb81d3add,0xb8723aa7,0xb8ec3a4f,0xb95f39ed,0xb9cb3984
    .long 0xb9a839a8,0xba2f3913,0xbaa73872,0xbb0e378b,0xbaa73872,0xbb253732,0xbb883564,0xbbce3303
    .long 0xbb64361f,0xbbc333c6,0xbbf62e46,0xbbfeaa48,0xbbd9323e,0xbbff2648,0xbbeab0b2,0xbb99b505
    .long 0xbc000000,0xbbd9b23e,0xbb64b61f,0xbaa7b872,0xbbd9b23e,0xbb50b67c,0xba6db8c4,0xb93aba0f
    .long 0xbb64b61f,0xba6db8c4,0xb913ba2f,0xb6d7bb3b,0xbaa7b872,0xb93aba0f,0xb6d7bb3b,0xb179bbe2
    .long 0xb9a8b9a8,0xb78bbb0e,0xb23ebbd9,0x2e46bbf6,0xb872baa7,0xb444bbb6,0x2a48bbfe,0x35c2bb77
    .long 0xb61fbb64,0xaa48bbfe,0x34a5bba8,0x38c4ba6d,0xb23ebbd9,0x3179bbe2,0x381dbadd,0x3a4fb8ec
    .long 0x80003c00,0x80003c00,0x80003c00,0x80003c00,0xb4a53ba8,0xb5053b99,0xb5643b88,0xb5c23b77
    .long 0xb8723aa7,0xb8c43a6d,0xb9133a2f,0xb95f39ed,0xba2f3913,0xba8a389b,0xbadd381d,0xbb253732
    .long 0xbb64361f,0xbba834a5,0xbbd9323e,0xbbf62e46,0xbbf62e46,0xbbffa648,0xbbeab0b2,0xbbb6b444
    .long 0xbbd9b23e,0xbb88b564,0xbb0eb78b,0xba6db8c4,0xbb0eb78b,0xba4fb8ec,0xb95fb9ed,0xb848bac2
    .long 0xb9a8b9a8,0xb872baa7,0xb61fbb64,0xb23ebbd9,0xb78bbb0e,0xb444bbb6,0xaa48bbfe,0x3179bbe2
    .long 0xb23ebbd9,0x2a48bbfe,0x34a5bba8,0x381dbadd,0x2e46bbf6,0x35c2bb77,0x38c4ba6d,0x3a4fb8ec
    .long 0x361fbb64,0x3913ba2f,0x3aa7b872,0x3ba8b4a5,0x3913ba2f,0x3ac2b848,0x3bc3b3c6,0x3bfa2cb5
    .long 0x3aa7b872,0x3bc3b3c6,0x3bf62e46,0x3b3b36d7,0x3ba8b4a5,0x3bfa2cb5,0x3b3b36d7,0x398439cb
    .long 0x3c00,0x3c00,0x3c00,0x3c00,0x3c008000,0x3c008000,0x3c008000,0x3c008000
    .long 0x3c00,0x361f3b64,0x39a839a8,0x3b64361f,0x3c008000,0x3b64b61f,0x39a8b9a8,0x361fbb64
    .long 0x3c00,0x3c000000,0xbc00,0xbc008000,0x3c008000,0xbc00,0xbc008000,0x80003c00
    .long 0x3c00,0x3b64b61f,0xb9a8b9a8,0xb61f3b64,0x3c008000,0xb61fbb64,0xb9a839a8,0x3b64361f
    .long 0x3c00,0xbc00,0x3c00,0xbc00,0x3c008000,0xbc008000,0x3c008000,0xbc008000
    .long 0x3c00,0xb61fbb64,0x39a839a8,0xbb64b61f,0x3c008000,0xbb64361f,0x39a8b9a8,0xb61f3b64
    .long 0x3c00,0xbc008000,0xbc00,0x3c000000,0x3c008000,0x80003c00,0xbc008000,0xbc00
    .long 0x3c00,0xbb64361f,0xb9a8b9a8,0x361fbb64,0x3c008000,0x361f3b64,0xb9a839a8,0xbb64b61f
    .long 0x3c00,0x3c00,0x3c00,0x3c00,0x3c008000,0x3c008000,0x3c008000,0x3c008000
    .long 0x3c000000,0x3b64b61f,0x39a8b9a8,0x361fbb64,0xbc00,0xb61fbb64,0xb9a8b9a8,0xbb64b61f
    .long 0x3c00,0x3c000000,0xbc00,0xbc008000,0x3c008000,0xbc00,0xbc008000,0x80003c00
    .long 0x3c000000,0xb61fbb64,0xb9a839a8,0x3b64361f,0xbc00,0xbb64361f,0x39a839a8,0x361fbb64
    .long 0x3c00,0xbc00,0x3c00,0xbc00,0x3c008000,0xbc008000,0x3c008000,0xbc008000
    .long 0x3c000000,0xbb64361f,0x39a8b9a8,0xb61f3b64,0xbc00,0x361f3b64,0xb9a8b9a8,0x3b64361f
    .long 0x3c00,0xbc008000,0xbc00,0x3c000000,0x3c008000,0x80003c00,0xbc008000,0xbc00
    .long 0x3c000000,0x361f3b64,0xb9a839a8,0xbb64b61f,0xbc00,0x3b64b61f,0x39a839a8,0xb61f3b64
    .long 0x3c00,0x3c00,0x3c00,0x3c00,0x3c008000,0x3c008000,0x3c008000,0x3c008000
    .long 0xbc00,0xb61fbb64,0xb9a8b9a8,0xbb64b61f,0xbc008000,0xbb64361f,0xb9a839a8,0xb61f3b64
    .long 0x3c00,0x3c000000,0xbc00,0xbc008000,0x3c008000,0xbc00,0xbc008000,0x80003c00
    .long 0xbc00,0xbb64361f,0x39a839a8,0x361fbb64,0xbc008000,0x361f3b64,0x39a8b9a8,0xbb64b61f
    .long 0x3c00,0xbc00,0x3c00,0xbc00,0x3c008000,0xbc008000,0x3c008000,0xbc008000
    .long 0xbc00,0x361f3b64,0xb9a8b9a8,0x3b64361f,0xbc008000,0x3b64b61f,0xb9a839a8,0x361fbb64
    .long 0x3c00,0xbc008000,0xbc00,0x3c000000,0x3c008000,0x80003c00,0xbc008000,0xbc00
    .long 0xbc00,0x3b64b61f,0x39a839a8,0xb61f3b64,0xbc008000,0xb61fbb64,0x39a8b9a8,0x3b64361f
    .long 0x3c00,0x3c00,0x3c00,0x3c00,0x3c008000,0x3c008000,0x3c008000,0x3c008000
    .long 0xbc008000,0xbb64361f,0xb9a839a8,0xb61f3b64,0x80003c00,0x361f3b64,0x39a839a8,0x3b64361f
    .long 0x3c00,0x3c000000,0xbc00,0xbc008000,0x3c008000,0xbc00,0xbc008000,0x80003c00
    .long 0xbc008000,0x361f3b64,0x39a8b9a8,0xbb64b61f,0x80003c00,0x3b64b61f,0xb9a8b9a8,0xb61f3b64
    .long 0x3c00,0xbc00,0x3c00,0xbc00,0x3c008000,0xbc008000,0x3c008000,0xbc008000
    .long 0xbc008000,0x3b64b61f,0xb9a839a8,0x361fbb64,0x80003c00,0xb61fbb64,0x39a839a8,0xbb64b61f
    .long 0x3c00,0xbc008000,0xbc00,0x3c000000,0x3c008000,0x80003c00,0xbc008000,0xbc00
    .long 0xbc008000,0xb61fbb64,0x39a8b9a8,0x3b64361f,0x80003c00,0xbb64361f,0xb9a8b9a8,0x361fbb64
    .long 0x3c00,0x39a839a8,0x3c000000,0x39a8b9a8,0x3c008000,0x39a8b9a8,0xbc00,0xb9a8b9a8
    .long 0x3c00,0x3b64361f,0x39a8b9a8,0xb61fbb64,0x3c008000,0x361fbb64,0xb9a8b9a8,0xbb64361f
    .long 0x3c00,0x39a8b9a8,0xbc008000,0x39a839a8,0x3c008000,0xb9a8b9a8,0x80003c00,0x39a8b9a8
    .long 0x3c00,0x361fbb64,0xb9a839a8,0x3b64b61f,0x3c008000,0xbb64b61f,0x39a839a8,0xb61fbb64
    .long 0x3c00,0xb9a8b9a8,0x3c000000,0xb9a839a8,0x3c008000,0xb9a839a8,0xbc00,0x39a839a8
    .long 0x3c00,0xbb64b61f,0x39a8b9a8,0x361f3b64,0x3c008000,0xb61f3b64,0xb9a8b9a8,0x3b64b61f
    .long 0x3c00,0xb9a839a8,0xbc008000,0xb9a8b9a8,0x3c008000,0x39a839a8,0x80003c00,0xb9a839a8
    .long 0x3c00,0xb61f3b64,0xb9a839a8,0xbb64361f,0x3c008000,0x3b64361f,0x39a839a8,0x361f3b64
    .long 0xbc00,0xb9a8b9a8,0xbc008000,0xb9a839a8,0xbc008000,0xb9a839a8,0x80003c00,0x39a839a8
    .long 0xbc008000,0xb61f3b64,0x39a839a8,0x3b64b61f,0x80003c00,0x3b64361f,0x39a8b9a8,0xb61fbb64
    .long 0xbc00,0xb9a839a8,0x3c000000,0xb9a8b9a8,0xbc008000,0x39a839a8,0xbc00,0xb9a839a8
    .long 0xbc008000,0x3b64361f,0xb9a8b9a8,0x361f3b64,0x80003c00,0x361fbb64,0xb9a839a8,0x3b64b61f
    .long 0xbc00,0x39a839a8,0xbc008000,0x39a8b9a8,0xbc008000,0x39a8b9a8,0x80003c00,0xb9a8b9a8
    .long 0xbc008000,0x361fbb64,0x39a839a8,0xbb64361f,0x80003c00,0xbb64b61f,0x39a8b9a8,0x361f3b64
    .long 0xbc00,0x39a8b9a8,0x3c000000,0x39a839a8,0xbc008000,0xb9a8b9a8,0xbc00,0x39a8b9a8
    .long 0xbc008000,0xbb64b61f,0xb9a8b9a8,0xb61fbb64,0x80003c00,0xb61f3b64,0xb9a839a8,0xbb64361f
    .long 0x3c00,0x39a839a8,0x3c000000,0x39a8b9a8,0x3c008000,0x39a8b9a8,0xbc00,0xb9a8b9a8
    .long 0xbc00,0xbb64b61f,0xb9a839a8,0x361f3b64,0xbc008000,0xb61f3b64,0x39a839a8,0x3b64b61f
    .long 0x3c00,0x39a8b9a8,0xbc008000,0x39a839a8,0x3c008000,0xb9a8b9a8,0x80003c00,0x39a8b9a8
    .long 0xbc00,0xb61f3b64,0x39a8b9a8,0xbb64361f,0xbc008000,0x3b64361f,0xb9a8b9a8,0x361f3b64
    .long 0x3c00,0xb9a8b9a8,0x3c000000,0xb9a839a8,0x3c008000,0xb9a839a8,0xbc00,0x39a839a8
    .long 0xbc00,0x3b64361f,0xb9a839a8,0xb61fbb64,0xbc008000,0x361fbb64,0x39a839a8,0xbb64361f
    .long 0x3c00,0xb9a839a8,0xbc008000,0xb9a8b9a8,0x3c008000,0x39a839a8,0x80003c00,0xb9a839a8
    .long 0xbc00,0x361fbb64,0x39a8b9a8,0x3b64b61f,0xbc008000,0xbb64b61f,0xb9a8b9a8,0xb61fbb64
    .long 0xbc00,0xb9a8b9a8,0xbc008000,0xb9a839a8,0xbc008000,0xb9a839a8,0x80003c00,0x39a839a8
    .long 0x3c000000,0x361fbb64,0xb9a8b9a8,0xbb64361f,0xbc00,0xbb64b61f,0xb9a839a8,0x361f3b64
    .long 0xbc00,0xb9a839a8,0x3c000000,0xb9a8b9a8,0xbc008000,0x39a839a8,0xbc00,0xb9a839a8
    .long 0x3c000000,0xbb64b61f,0x39a839a8,0xb61fbb64,0xbc00,0xb61f3b64,0x39a8b9a8,0xbb64361f
    .long 0xbc00,0x39a839a8,0xbc008000,0x39a8b9a8,0xbc008000,0x39a8b9a8,0x80003c00,0xb9a8b9a8
    .long 0x3c000000,0xb61f3b64,0xb9a8b9a8,0x3b64b61f,0xbc00,0x3b64361f,0xb9a839a8,0xb61fbb64
    .long 0xbc00,0x39a8b9a8,0x3c000000,0x39a839a8,0xbc008000,0xb9a8b9a8,0xbc00,0x39a8b9a8
    .long 0x3c000000,0x3b64361f,0x39a839a8,0x361f3b64,0xbc00,0x361fbb64,0x39a8b9a8,0x3b64b61f
    .long 0x80003f80,0x80003f80,0x80003f80,0x80003f80,0x80003f80,0xbec43f6d,0xbf353f35,0xbf6d3ec4
    .long 0x80003f80,0xbf353f35,0xbf80248d,0xbf35bf35,0x80003f80,0xbf6d3ec4,0xbf35bf35,0x3ec4bf6d
    .long 0x80003f80,0xbf80248d,0xa50dbf80,0x3f80a554,0x80003f80,0xbf6dbec4,0x3f35bf35,0x3ec43f6d
    .long 0x80003f80,0xbf35bf35,0x3f80a554,0xbf353f35,0x80003f80,0xbec4bf6d,0x3f353f35,0xbf6dbec4
    .long 0x80003f80,0xa50dbf80,0x80003f80,0xa50dbf80,0x80003f80,0x3ec4bf6d,0xbf353f35,0x3f6dbec4
    .long 0x80003f80,0x3f35bf35,0xbf80248d,0x3f353f35,0x80003f80,0x3f6dbec4,0xbf35bf35,0xbec43f6d
    .long 0x80003f80,0x3f80a554,0xa50dbf80,0xbf80248d,0x80003f80,0x3f6d3ec4,0x3f35bf35,0xbec4bf6d
    .long 0x80003f80,0x3f353f35,0x3f80a554,0x3f35bf35,0x80003f80,0x3ec43f6d,0x3f353f35,0x3f6d3ec4
    .long 0x80003f80,0x80003f80,0x80003f80,0x80003f80,0xbf80248d,0xbf6dbec4,0xbf35bf35,0xbec4bf6d
    .long 0xa50dbf80,0x3f35bf35,0x3f80a554,0x3f353f35,0x3f80a554,0x3ec43f6d,0xbf353f35,0xbf6dbec4
    .long 0x80003f80,0xbf80248d,0xa50dbf80,0x3f80a554,0xbf80248d,0x3ec4bf6d,0x3f353f35,0xbf6d3ec4
    .long 0xa50dbf80,0x3f353f35,0xbf80248d,0x3f35bf35,0x3f80a554,0xbf6d3ec4,0x3f35bf35,0xbec43f6d
    .long 0x80003f80,0xa50dbf80,0x80003f80,0xa50dbf80,0xbf80248d,0x3f6d3ec4,0xbf35bf35,0x3ec43f6d
    .long 0xa50dbf80,0xbf353f35,0x3f80a554,0xbf35bf35,0x3f80a554,0xbec4bf6d,0xbf353f35,0x3f6d3ec4
    .long 0x80003f80,0x3f80a554,0xa50dbf80,0xbf80248d,0xbf80248d,0xbec43f6d,0x3f353f35,0x3f6dbec4
    .long 0xa50dbf80,0xbf35bf35,0xbf80248d,0xbf353f35,0x3f80a554,0x3f6dbec4,0x3f35bf35,0x3ec4bf6d
    .long 0x80003f80,0x80003f80,0x80003f80,0x80003f80,0xa50dbf80,0x3ec4bf6d,0x3f35bf35,0x3f6dbec4
    .long 0x80003f80,0xbf353f35,0xbf80248d,0xbf35bf35,0xa50dbf80,0x3f6dbec4,0x3f353f35,0xbec43f6d
    .long 0x80003f80,0xbf80248d,0xa50dbf80,0x3f80a554,0xa50dbf80,0x3f6d3ec4,0xbf353f35,0xbec4bf6d
    .long 0x80003f80,0xbf35bf35,0x3f80a554,0xbf353f35,0xa50dbf80,0x3ec43f6d,0xbf35bf35,0x3f6d3ec4
    .long 0x80003f80,0xa50dbf80,0x80003f80,0xa50dbf80,0xa50dbf80,0xbec43f6d,0x3f35bf35,0xbf6d3ec4
    .long 0x80003f80,0x3f35bf35,0xbf80248d,0x3f353f35,0xa50dbf80,0xbf6d3ec4,0x3f353f35,0x3ec4bf6d
    .long 0x80003f80,0x3f80a554,0xa50dbf80,0xbf80248d,0xa50dbf80,0xbf6dbec4,0xbf353f35,0x3ec43f6d
    .long 0x80003f80,0x3f353f35,0x3f80a554,0x3f35bf35,0xa50dbf80,0xbec4bf6d,0xbf35bf35,0xbf6dbec4
    .long 0x80003f80,0x80003f80,0x80003f80,0x80003f80,0x3f80a554,0x3f6d3ec4,0x3f353f35,0x3ec43f6d
    .long 0xa50dbf80,0x3f35bf35,0x3f80a554,0x3f353f35,0xbf80248d,0xbec4bf6d,0x3f35bf35,0x3f6d3ec4
    .long 0x80003f80,0xbf80248d,0xa50dbf80,0x3f80a554,0x3f80a554,0xbec43f6d,0xbf35bf35,0x3f6dbec4
    .long 0xa50dbf80,0x3f353f35,0xbf80248d,0x3f35bf35,0xbf80248d,0x3f6dbec4,0xbf353f35,0x3ec4bf6d
    .long 0x80003f80,0xa50dbf80,0x80003f80,0xa50dbf80,0x3f80a554,0xbf6dbec4,0x3f353f35,0xbec4bf6d
    .long 0xa50dbf80,0xbf353f35,0x3f80a554,0xbf35bf35,0xbf80248d,0x3ec43f6d,0x3f35bf35,0xbf6dbec4
    .long 0x80003f80,0x3f80a554,0xa50dbf80,0xbf80248d,0x3f80a554,0x3ec4bf6d,0xbf35bf35,0xbf6d3ec4
    .long 0xa50dbf80,0xbf35bf35,0xbf80248d,0xbf353f35,0xbf80248d,0xbf6d3ec4,0xbf353f35,0xbec43f6d
    .long 0x3f800000,0x3f800000,0x3f800000,0x3f800000,0x3f800000,0x3f6d3ec4,0x3f353f35,0x3ec43f6d
    .long 0x3f800000,0x3f353f35,0x248d3f80,0xbf353f35,0x3f800000,0x3ec43f6d,0xbf353f35,0xbf6dbec4
    .long 0x3f800000,0x248d3f80,0xbf80250d,0xa554bf80,0x3f800000,0xbec43f6d,0xbf35bf35,0x3f6dbec4
    .long 0x3f800000,0xbf353f35,0xa554bf80,0x3f353f35,0x3f800000,0xbf6d3ec4,0x3f35bf35,0xbec43f6d
    .long 0x3f800000,0xbf80250d,0x3f800000,0xbf80250d,0x3f800000,0xbf6dbec4,0x3f353f35,0xbec4bf6d
    .long 0x3f800000,0xbf35bf35,0x248d3f80,0x3f35bf35,0x3f800000,0xbec4bf6d,0xbf353f35,0x3f6d3ec4
    .long 0x3f800000,0xa554bf80,0xbf80250d,0x248d3f80,0x3f800000,0x3ec4bf6d,0xbf35bf35,0xbf6d3ec4
    .long 0x3f800000,0x3f35bf35,0xa554bf80,0xbf35bf35,0x3f800000,0x3f6dbec4,0x3f35bf35,0x3ec4bf6d
    .long 0x3f800000,0x3f800000,0x3f800000,0x3f800000,0x248d3f80,0xbec43f6d,0xbf353f35,0xbf6d3ec4
    .long 0xbf80250d,0xbf35bf35,0xa554bf80,0x3f35bf35,0xa554bf80,0x3f6dbec4,0x3f353f35,0xbec43f6d
    .long 0x3f800000,0x248d3f80,0xbf80250d,0xa554bf80,0x248d3f80,0xbf6dbec4,0x3f35bf35,0x3ec43f6d
    .long 0xbf80250d,0x3f35bf35,0x248d3f80,0xbf35bf35,0xa554bf80,0x3ec43f6d,0xbf35bf35,0x3f6d3ec4
    .long 0x3f800000,0xbf80250d,0x3f800000,0xbf80250d,0x248d3f80,0x3ec4bf6d,0xbf353f35,0x3f6dbec4
    .long 0xbf80250d,0x3f353f35,0xa554bf80,0xbf353f35,0xa554bf80,0xbf6d3ec4,0x3f353f35,0x3ec4bf6d
    .long 0x3f800000,0xa554bf80,0xbf80250d,0x248d3f80,0x248d3f80,0x3f6d3ec4,0x3f35bf35,0xbec4bf6d
    .long 0xbf80250d,0xbf353f35,0x248d3f80,0x3f353f35,0xa554bf80,0xbec4bf6d,0xbf35bf35,0xbf6dbec4
    .long 0x3f800000,0x3f800000,0x3f800000,0x3f800000,0xbf80250d,0xbf6dbec4,0xbf35bf35,0xbec4bf6d
    .long 0x3f800000,0x3f353f35,0x248d3f80,0xbf353f35,0xbf80250d,0xbec4bf6d,0x3f35bf35,0x3f6d3ec4
    .long 0x3f800000,0x248d3f80,0xbf80250d,0xa554bf80,0xbf80250d,0x3ec4bf6d,0x3f353f35,0xbf6d3ec4
    .long 0x3f800000,0xbf353f35,0xa554bf80,0x3f353f35,0xbf80250d,0x3f6dbec4,0xbf353f35,0x3ec4bf6d
    .long 0x3f800000,0xbf80250d,0x3f800000,0xbf80250d,0xbf80250d,0x3f6d3ec4,0xbf35bf35,0x3ec43f6d
    .long 0x3f800000,0xbf35bf35,0x248d3f80,0x3f35bf35,0xbf80250d,0x3ec43f6d,0x3f35bf35,0xbf6dbec4
    .long 0x3f800000,0xa554bf80,0xbf80250d,0x248d3f80,0xbf80250d,0xbec43f6d,0x3f353f35,0x3f6dbec4
    .long 0x3f800000,0x3f35bf35,0xa554bf80,0xbf35bf35,0xbf80250d,0xbf6d3ec4,0xbf353f35,0xbec43f6d
    .long 0x3f800000,0x3f800000,0x3f800000,0x3f800000,0xa554bf80,0x3ec4bf6d,0x3f35bf35,0x3f6dbec4
    .long 0xbf80250d,0xbf35bf35,0xa554bf80,0x3f35bf35,0x248d3f80,0xbf6d3ec4,0xbf35bf35,0x3ec4bf6d
    .long 0x3f800000,0x248d3f80,0xbf80250d,0xa554bf80,0xa554bf80,0x3f6d3ec4,0xbf353f35,0xbec4bf6d
    .long 0xbf80250d,0x3f35bf35,0x248d3f80,0xbf35bf35,0x248d3f80,0xbec4bf6d,0x3f353f35,0xbf6dbec4
    .long 0x3f800000,0xbf80250d,0x3f800000,0xbf80250d,0xa554bf80,0xbec43f6d,0x3f35bf35,0xbf6d3ec4
    .long 0xbf80250d,0x3f353f35,0xa554bf80,0xbf353f35,0x248d3f80,0x3f6dbec4,0xbf35bf35,0xbec43f6d
    .long 0x3f800000,0xa554bf80,0xbf80250d,0x248d3f80,0xa554bf80,0xbf6dbec4,0xbf353f35,0x3ec43f6d
    .long 0xbf80250d,0xbf353f35,0x248d3f80,0x3f353f35,0x248d3f80,0x3ec43f6d,0x3f353f35,0x3f6d3ec4
    .long 0x3f800000,0x0,0x3f800000,0x0,0x3f800000,0x0,0x3f7fec43,0x3cc90ab0
    .long 0x3f800000,0x0,0x3f7fb10f,0x3d48fb30,0x3f800000,0x0,0x3f7f4e6d,0x3d96a905
    .long 0x3f800000,0x0,0x3f7ec46d,0x3dc8bd36,0x3f800000,0x0,0x3f7e1324,0x3dfab273
    .long 0x3f800000,0x0,0x3f7d3aac,0x3e164083,0x3f800000,0x0,0x3f7c3b28,0x3e2f10a2
    .long 0x3f800000,0x0,0x3f7b14be,0x3e47c5c2,0x3f800000,0x0,0x3f79c79d,0x3e605c13
    .long 0x3f800000,0x0,0x3f7853f8,0x3e78cfcc,0x3f800000,0x0,0x3f76ba07,0x3e888e93
    .long 0x3f800000,0x0,0x3f74fa0b,0x3e94a031,0x3f800000,0x0,0x3f731447,0x3ea09ae5
    .long 0x3f800000,0x0,0x3f710908,0x3eac7cd4,0x3f800000,0x0,0x3f6ed89e,0x3eb8442a
    .long 0x3f800000,0x0,0x3f800000,0x0,0x3f7ec46d,0x3dc8bd36,0x3f7e1324,0x3dfab273
    .long 0x3f7b14be,0x3e47c5c2,0x3f7853f8,0x3e78cfcc,0x3f74fa0b,0x3e94a031,0x3f6ed89e,0x3eb8442a
    .long 0x3f6c835e,0x3ec3ef15,0x3f61c598,0x3ef15aea,0x3f61c598,0x3ef15aea,0x3f514d3d,0x3f13682a
    .long 0x3f54db31,0x3f0e39da,0x3f3daef9,0x3f2beb4a,0x3f45e403,0x3f226799,0x3f273656,0x3f41d870
    .long 0x3f3504f3,0x3f3504f3,0x3f0e39da,0x3f54db31,0x3f226799,0x3f45e403,0x3ee63375,0x3f64aa59
    .long 0x3f0e39da,0x3f54db31,0x3eac7cd4,0x3f710908,0x3ef15aea,0x3f61c598,0x3e605c13,0x3f79c79d
    .long 0x3ec3ef15,0x3f6c835e,0x3dc8bd36,0x3f7ec46d,0x3e94a031,0x3f74fa0b,0xbcc90ab0,0x3f7fec43
    .long 0x3e47c5c2,0x3f7b14be,0xbe164083,0x3f7d3aac,0x3dc8bd36,0x3f7ec46d,0xbe888e93,0x3f76ba07
    .long 0x3f800000,0x0,0x3f800000,0x0,0x3f7b14be,0x3e47c5c2,0x3f79c79d,0x3e605c13
    .long 0x3f6c835e,0x3ec3ef15,0x3f676bd8,0x3edae880,0x3f54db31,0x3f0e39da,0x3f49d112,0x3f1d7fd1
    .long 0x3f3504f3,0x3f3504f3,0x3f226799,0x3f45e403,0x3f0e39da,0x3f54db31,0x3ee63375,0x3f64aa59
    .long 0x3ec3ef15,0x3f6c835e,0x3e78cfcc,0x3f7853f8,0x3e47c5c2,0x3f7b14be,0x3cc90ab0,0x3f7fec43
    .long 0x248d3132,0x3f800000,0xbe47c5c2,0x3f7b14be,0xbe47c5c2,0x3f7b14be,0xbecf7bca,0x3f6a09a7
    .long 0xbec3ef15,0x3f6c835e,0xbf187fc0,0x3f4d9f02,0xbf0e39da,0x3f54db31,0xbf41d870,0x3f273656
    .long 0xbf3504f3,0x3f3504f3,0xbf61c598,0x3ef15aea,0xbf54db31,0x3f0e39da,0xbf76ba07,0x3e888e93
    .long 0xbf6c835e,0x3ec3ef15,0xbf7fb10f,0x3d48fb30,0xbf7b14be,0x3e47c5c2,0xbf7c3b28,0xbe2f10a2
    .long 0x3f800000,0x0,0x3f800000,0x0,0x3f74fa0b,0x3e94a031,0x3f731447,0x3ea09ae5
    .long 0x3f54db31,0x3f0e39da,0x3f4d9f02,0x3f187fc0,0x3f226799,0x3f45e403,0x3f13682a,0x3f514d3d
    .long 0x3ec3ef15,0x3f6c835e,0x3e94a031,0x3f74fa0b,0x3dc8bd36,0x3f7ec46d,0xbcc90ab0,0x3f7fec43
    .long 0xbe47c5c2,0x3f7b14be,0xbeac7cd4,0x3f710908,0xbef15aea,0x3f61c598,0xbf1d7fd1,0x3f49d112
    .long 0xbf3504f3,0x3f3504f3,0xbf54db31,0x3f0e39da,0xbf61c598,0x3ef15aea,0xbf76ba07,0x3e888e93
    .long 0xbf7b14be,0x3e47c5c2,0xbf7fb10f,0xbd48fb30,0xbf7ec46d,0xbdc8bd36,0xbf6ed89e,0xbeb8442a
    .long 0xbf6c835e,0xbec3ef15,0xbf45e403,0xbf226799,0xbf45e403,0xbf226799,0xbf08f59b,0xbf584853
    .long 0xbf0e39da,0xbf54db31,0xbe78cfcc,0xbf7853f8,0xbe94a031,0xbf74fa0b,0x3d96a905,0xbf7f4e6d
    .long 0x3f800000,0x0,0x3f800000,0x0,0x3f7fb10f,0x3d48fb30,0x3f7f4e6d,0x3d96a905
    .long 0x3f7ec46d,0x3dc8bd36,0x3f7d3aac,0x3e164083,0x3f7d3aac,0x3e164083,0x3f79c79d,0x3e605c13
    .long 0x3f7b14be,0x3e47c5c2,0x3f74fa0b,0x3e94a031,0x3f7853f8,0x3e78cfcc,0x3f6ed89e,0x3eb8442a
    .long 0x3f74fa0b,0x3e94a031,0x3f676bd8,0x3edae880,0x3f710908,0x3eac7cd4,0x3f5ebe05,0x3efc5d27
    .long 0x3f6c835e,0x3ec3ef15,0x3f54db31,0x3f0e39da,0x3f676bd8,0x3edae880,0x3f49d112,0x3f1d7fd1
    .long 0x3f61c598,0x3ef15aea,0x3f3daef9,0x3f2beb4a,0x3f5b941a,0x3f039c3d,0x3f3085bb,0x3f396842
    .long 0x3f54db31,0x3f0e39da,0x3f226799,0x3f45e403,0x3f4d9f02,0x3f187fc0,0x3f13682a,0x3f514d3d
    .long 0x3f45e403,0x3f226799,0x3f039c3d,0x3f5b941a,0x3f3daef9,0x3f2beb4a,0x3ee63375,0x3f64aa59
    .long 0x3f800000,0x0,0x3f800000,0x0,0x3f7d3aac,0x3e164083,0x3f7c3b28,0x3e2f10a2
    .long 0x3f74fa0b,0x3e94a031,0x3f710908,0x3eac7cd4,0x3f676bd8,0x3edae880,0x3f5ebe05,0x3efc5d27
    .long 0x3f54db31,0x3f0e39da,0x3f45e403,0x3f226799,0x3f3daef9,0x3f2beb4a,0x3f273656,0x3f41d870
    .long 0x3f226799,0x3f45e403,0x3f039c3d,0x3f5b941a,0x3f039c3d,0x3f5b941a,0x3eb8442a,0x3f6ed89e
    .long 0x3ec3ef15,0x3f6c835e,0x3e47c5c2,0x3f7b14be,0x3e78cfcc,0x3f7853f8,0x3cc90ab0,0x3f7fec43
    .long 0x3dc8bd36,0x3f7ec46d,0xbe164083,0x3f7d3aac,0xbd48fb30,0x3f7fb10f,0xbea09ae5,0x3f731447
    .long 0xbe47c5c2,0x3f7b14be,0xbef15aea,0x3f61c598,0xbeac7cd4,0x3f710908,0xbf1d7fd1,0x3f49d112
    .long 0xbef15aea,0x3f61c598,0xbf3daef9,0x3f2beb4a,0xbf187fc0,0x3f4d9f02,0xbf584853,0x3f08f59b
    .long 0x3f800000,0x0,0x3f800000,0x0,0x3f7853f8,0x3e78cfcc,0x3f76ba07,0x3e888e93
    .long 0x3f61c598,0x3ef15aea,0x3f5b941a,0x3f039c3d,0x3f3daef9,0x3f2beb4a,0x3f3085bb,0x3f396842
    .long 0x3f0e39da,0x3f54db31,0x3ef15aea,0x3f61c598,0x3eac7cd4,0x3f710908,0x3e605c13,0x3f79c79d
    .long 0x3dc8bd36,0x3f7ec46d,0xbd48fb30,0x3f7fb10f,0xbe164083,0x3f7d3aac,0xbea09ae5,0x3f731447
    .long 0xbec3ef15,0x3f6c835e,0xbf0e39da,0x3f54db31,0xbf187fc0,0x3f4d9f02,0xbf41d870,0x3f273656
    .long 0xbf45e403,0x3f226799,0xbf676bd8,0x3edae880,0xbf676bd8,0x3edae880,0xbf7c3b28,0x3e2f10a2
    .long 0xbf7b14be,0x3e47c5c2,0xbf7ec46d,0xbdc8bd36,0xbf7fb10f,0xbd48fb30,0xbf6ed89e,0xbeb8442a
    .long 0xbf74fa0b,0xbe94a031,0xbf4d9f02,0xbf187fc0,0xbf5b941a,0xbf039c3d,0xbf1d7fd1,0xbf49d112
    .long 0x3f800000,0x0,0x3f800000,0x0,0x3f710908,0x3eac7cd4,0x3f6ed89e,0x3eb8442a
    .long 0x3f45e403,0x3f226799,0x3f3daef9,0x3f2beb4a,0x3f039c3d,0x3f5b941a,0x3ee63375,0x3f64aa59
    .long 0x3e47c5c2,0x3f7b14be,0x3dc8bd36,0x3f7ec46d,0xbe164083,0x3f7d3aac,0xbe888e93,0x3f76ba07
    .long 0xbef15aea,0x3f61c598,0xbf187fc0,0x3f4d9f02,0xbf3daef9,0x3f2beb4a,0xbf584853,0x3f08f59b
    .long 0xbf6c835e,0x3ec3ef15,0xbf7b14be,0x3e47c5c2,0xbf7fb10f,0x3d48fb30,0xbf7c3b28,0xbe2f10a2
    .long 0xbf74fa0b,0xbe94a031,0xbf5b941a,0xbf039c3d,0xbf4d9f02,0xbf187fc0,0xbf1d7fd1,0xbf49d112
    .long 0xbf0e39da,0xbf54db31,0xbe94a031,0xbf74fa0b,0xbe78cfcc,0xbf7853f8,0x3d96a905,0xbf7f4e6d
    .long 0x3dc8bd36,0xbf7ec46d,0x3edae880,0xbf676bd8,0x3edae880,0xbf676bd8,0x3f396842,0xbf3085bb
    .long 0x80003f80,0x80003f80,0x80003f80,0x80003f80,0x3f800000,0x3f800000,0x3f800000,0x3f800000
    .long 0x80003f80,0xbec43f6d,0xbf353f35,0xbf6d3ec4,0x3f800000,0x3f6d3ec4,0x3f353f35,0x3ec43f6d
    .long 0x80003f80,0xbf80248d,0xa50dbf80,0x3f80a554,0x3f800000,0x248d3f80,0xbf80250d,0xa554bf80
    .long 0x80003f80,0xbf6dbec4,0x3f35bf35,0x3ec43f6d,0x3f800000,0xbec43f6d,0xbf35bf35,0x3f6dbec4
    .long 0x80003f80,0xa50dbf80,0x80003f80,0xa50dbf80,0x3f800000,0xbf80250d,0x3f800000,0xbf80250d
    .long 0x80003f80,0x3ec4bf6d,0xbf353f35,0x3f6dbec4,0x3f800000,0xbf6dbec4,0x3f353f35,0xbec4bf6d
    .long 0x80003f80,0x3f80a554,0xa50dbf80,0xbf80248d,0x3f800000,0xa554bf80,0xbf80250d,0x248d3f80
    .long 0x80003f80,0x3f6d3ec4,0x3f35bf35,0xbec4bf6d,0x3f800000,0x3ec4bf6d,0xbf35bf35,0xbf6d3ec4
    .long 0x80003f80,0x80003f80,0x80003f80,0x80003f80,0x3f800000,0x3f800000,0x3f800000,0x3f800000
    .long 0xbf80248d,0xbf6dbec4,0xbf35bf35,0xbec4bf6d,0x248d3f80,0xbec43f6d,0xbf353f35,0xbf6d3ec4
    .long 0x80003f80,0xbf80248d,0xa50dbf80,0x3f80a554,0x3f800000,0x248d3f80,0xbf80250d,0xa554bf80
    .long 0xbf80248d,0x3ec4bf6d,0x3f353f35,0xbf6d3ec4,0x248d3f80,0xbf6dbec4,0x3f35bf35,0x3ec43f6d
    .long 0x80003f80,0xa50dbf80,0x80003f80,0xa50dbf80,0x3f800000,0xbf80250d,0x3f800000,0xbf80250d
    .long 0xbf80248d,0x3f6d3ec4,0xbf35bf35,0x3ec43f6d,0x248d3f80,0x3ec4bf6d,0xbf353f35,0x3f6dbec4
    .long 0x80003f80,0x3f80a554,0xa50dbf80,0xbf80248d,0x3f800000,0xa554bf80,0xbf80250d,0x248d3f80
    .long 0xbf80248d,0xbec43f6d,0x3f353f35,0x3f6dbec4,0x248d3f80,0x3f6d3ec4,0x3f35bf35,0xbec4bf6d
    .long 0x80003f80,0x80003f80,0x80003f80,0x80003f80,0x3f800000,0x3f800000,0x3f800000,0x3f800000
    .long 0xa50dbf80,0x3ec4bf6d,0x3f35bf35,0x3f6dbec4,0xbf80250d,0xbf6dbec4,0xbf35bf35,0xbec4bf6d
    .long 0x80003f80,0xbf80248d,0xa50dbf80,0x3f80a554,0x3f800000,0x248d3f80,0xbf80250d,0xa554bf80
    .long 0xa50dbf80,0x3f6d3ec4,0xbf353f35,0xbec4bf6d,0xbf80250d,0x3ec4bf6d,0x3f353f35,0xbf6d3ec4
    .long 0x80003f80,0xa50dbf80,0x80003f80,0xa50dbf80,0x3f800000,0xbf80250d,0x3f800000,0xbf80250d
    .long 0xa50dbf80,0xbec43f6d,0x3f35bf35,0xbf6d3ec4,0xbf80250d,0x3f6d3ec4,0xbf35bf35,0x3ec43f6d
    .long 0x80003f80,0x3f80a554,0xa50dbf80,0xbf80248d,0x3f800000,0xa554bf80,0xbf80250d,0x248d3f80
    .long 0xa50dbf80,0xbf6dbec4,0xbf353f35,0x3ec43f6d,0xbf80250d,0xbec43f6d,0x3f353f35,0x3f6dbec4
    .long 0x80003f80,0x80003f80,0x80003f80,0x80003f80,0x3f800000,0x3f800000,0x3f800000,0x3f800000
    .long 0x3f80a554,0x3f6d3ec4,0x3f353f35,0x3ec43f6d,0xa554bf80,0x3ec4bf6d,0x3f35bf35,0x3f6dbec4
    .long 0x80003f80,0xbf80248d,0xa50dbf80,0x3f80a554,0x3f800000,0x248d3f80,0xbf80250d,0xa554bf80
    .long 0x3f80a554,0xbec43f6d,0xbf35bf35,0x3f6dbec4,0xa554bf80,0x3f6d3ec4,0xbf353f35,0xbec4bf6d
    .long 0x80003f80,0xa50dbf80,0x80003f80,0xa50dbf80,0x3f800000,0xbf80250d,0x3f800000,0xbf80250d
    .long 0x3f80a554,0xbf6dbec4,0x3f353f35,0xbec4bf6d,0xa554bf80,0xbec43f6d,0x3f35bf35,0xbf6d3ec4
    .long 0x80003f80,0x3f80a554,0xa50dbf80,0xbf80248d,0x3f800000,0xa554bf80,0xbf80250d,0x248d3f80
    .long 0x3f80a554,0x3ec4bf6d,0xbf35bf35,0xbf6d3ec4,0xa554bf80,0xbf6dbec4,0xbf353f35,0x3ec43f6d
    .long 0x80003f80,0xbf353f35,0xbf80248d,0xbf35bf35,0x3f800000,0x3f353f35,0x248d3f80,0xbf353f35
    .long 0x80003f80,0xbf6d3ec4,0xbf35bf35,0x3ec4bf6d,0x3f800000,0x3ec43f6d,0xbf353f35,0xbf6dbec4
    .long 0x80003f80,0xbf35bf35,0x3f80a554,0xbf353f35,0x3f800000,0xbf353f35,0xa554bf80,0x3f353f35
    .long 0x80003f80,0xbec4bf6d,0x3f353f35,0xbf6dbec4,0x3f800000,0xbf6d3ec4,0x3f35bf35,0xbec43f6d
    .long 0x80003f80,0x3f35bf35,0xbf80248d,0x3f353f35,0x3f800000,0xbf35bf35,0x248d3f80,0x3f35bf35
    .long 0x80003f80,0x3f6dbec4,0xbf35bf35,0xbec43f6d,0x3f800000,0xbec4bf6d,0xbf353f35,0x3f6d3ec4
    .long 0x80003f80,0x3f353f35,0x3f80a554,0x3f35bf35,0x3f800000,0x3f35bf35,0xa554bf80,0xbf35bf35
    .long 0x80003f80,0x3ec43f6d,0x3f353f35,0x3f6d3ec4,0x3f800000,0x3f6dbec4,0x3f35bf35,0x3ec4bf6d
    .long 0xa50dbf80,0x3f35bf35,0x3f80a554,0x3f353f35,0xbf80250d,0xbf35bf35,0xa554bf80,0x3f35bf35
    .long 0x3f80a554,0x3ec43f6d,0xbf353f35,0xbf6dbec4,0xa554bf80,0x3f6dbec4,0x3f353f35,0xbec43f6d
    .long 0xa50dbf80,0x3f353f35,0xbf80248d,0x3f35bf35,0xbf80250d,0x3f35bf35,0x248d3f80,0xbf35bf35
    .long 0x3f80a554,0xbf6d3ec4,0x3f35bf35,0xbec43f6d,0xa554bf80,0x3ec43f6d,0xbf35bf35,0x3f6d3ec4
    .long 0xa50dbf80,0xbf353f35,0x3f80a554,0xbf35bf35,0xbf80250d,0x3f353f35,0xa554bf80,0xbf353f35
    .long 0x3f80a554,0xbec4bf6d,0xbf353f35,0x3f6d3ec4,0xa554bf80,0xbf6d3ec4,0x3f353f35,0x3ec4bf6d
    .long 0xa50dbf80,0xbf35bf35,0xbf80248d,0xbf353f35,0xbf80250d,0xbf353f35,0x248d3f80,0x3f353f35
    .long 0x3f80a554,0x3f6dbec4,0x3f35bf35,0x3ec4bf6d,0xa554bf80,0xbec4bf6d,0xbf35bf35,0xbf6dbec4
    .long 0x80003f80,0xbf353f35,0xbf80248d,0xbf35bf35,0x3f800000,0x3f353f35,0x248d3f80,0xbf353f35
    .long 0xa50dbf80,0x3f6dbec4,0x3f353f35,0xbec43f6d,0xbf80250d,0xbec4bf6d,0x3f35bf35,0x3f6d3ec4
    .long 0x80003f80,0xbf35bf35,0x3f80a554,0xbf353f35,0x3f800000,0xbf353f35,0xa554bf80,0x3f353f35
    .long 0xa50dbf80,0x3ec43f6d,0xbf35bf35,0x3f6d3ec4,0xbf80250d,0x3f6dbec4,0xbf353f35,0x3ec4bf6d
    .long 0x80003f80,0x3f35bf35,0xbf80248d,0x3f353f35,0x3f800000,0xbf35bf35,0x248d3f80,0x3f35bf35
    .long 0xa50dbf80,0xbf6d3ec4,0x3f353f35,0x3ec4bf6d,0xbf80250d,0x3ec43f6d,0x3f35bf35,0xbf6dbec4
    .long 0x80003f80,0x3f353f35,0x3f80a554,0x3f35bf35,0x3f800000,0x3f35bf35,0xa554bf80,0xbf35bf35
    .long 0xa50dbf80,0xbec4bf6d,0xbf35bf35,0xbf6dbec4,0xbf80250d,0xbf6d3ec4,0xbf353f35,0xbec43f6d
    .long 0xa50dbf80,0x3f35bf35,0x3f80a554,0x3f353f35,0xbf80250d,0xbf35bf35,0xa554bf80,0x3f35bf35
    .long 0xbf80248d,0xbec4bf6d,0x3f35bf35,0x3f6d3ec4,0x248d3f80,0xbf6d3ec4,0xbf35bf35,0x3ec4bf6d
    .long 0xa50dbf80,0x3f353f35,0xbf80248d,0x3f35bf35,0xbf80250d,0x3f35bf35,0x248d3f80,0xbf35bf35
    .long 0xbf80248d,0x3f6dbec4,0xbf353f35,0x3ec4bf6d,0x248d3f80,0xbec4bf6d,0x3f353f35,0xbf6dbec4
    .long 0xa50dbf80,0xbf353f35,0x3f80a554,0xbf35bf35,0xbf80250d,0x3f353f35,0xa554bf80,0xbf353f35
    .long 0xbf80248d,0x3ec43f6d,0x3f35bf35,0xbf6dbec4,0x248d3f80,0x3f6dbec4,0xbf35bf35,0xbec43f6d
    .long 0xa50dbf80,0xbf35bf35,0xbf80248d,0xbf353f35,0xbf80250d,0xbf353f35,0x248d3f80,0x3f353f35
    .long 0xbf80248d,0xbf6d3ec4,0xbf353f35,0xbec43f6d,0x248d3f80,0x3ec43f6d,0x3f353f35,0x3f6d3ec4
    .long 0x80003f80,0x80003f80,0x80003f80,0x80003f80,0x80003f80,0xbe483f7b,0xbec43f6d,0xbf0e3f55
    .long 0x80003f80,0xbec43f6d,0xbf353f35,0xbf6d3ec4,0x80003f80,0xbf0e3f55,0xbf6d3ec4,0xbf7bbe48
    .long 0x80003f80,0xbf80248d,0xa50dbf80,0x3f80a554,0x80003f80,0xbf7bbe48,0x3ec4bf6d,0x3f553f0e
    .long 0x80003f80,0xbf6dbec4,0x3f35bf35,0x3ec43f6d,0x80003f80,0xbf55bf0e,0x3f6dbec4,0xbe483f7b
    .long 0x80003f80,0xa50dbf80,0x80003f80,0xa50dbf80,0x80003f80,0x3e48bf7b,0xbec43f6d,0x3f0ebf55
    .long 0x80003f80,0x3ec4bf6d,0xbf353f35,0x3f6dbec4,0x80003f80,0x3f0ebf55,0xbf6d3ec4,0x3f7b3e48
    .long 0x80003f80,0x3f80a554,0xa50dbf80,0xbf80248d,0x80003f80,0x3f7b3e48,0x3ec4bf6d,0xbf55bf0e
    .long 0x80003f80,0x3f6d3ec4,0x3f35bf35,0xbec4bf6d,0x80003f80,0x3f553f0e,0x3f6dbec4,0x3e48bf7b
    .long 0x80003f80,0x80003f80,0x80003f80,0x80003f80,0xbf353f35,0xbf553f0e,0xbf6d3ec4,0xbf7b3e48
    .long 0xbf80248d,0xbf6dbec4,0xbf35bf35,0xbec4bf6d,0xbf35bf35,0xbe48bf7b,0x3ec4bf6d,0x3f55bf0e
    .long 0x80003f80,0xbf80248d,0xa50dbf80,0x3f80a554,0xbf353f35,0xbf0ebf55,0x3f6dbec4,0x3e483f7b
    .long 0xbf80248d,0x3ec4bf6d,0x3f353f35,0xbf6d3ec4,0xbf35bf35,0x3f7bbe48,0xbec43f6d,0xbf0ebf55
    .long 0x80003f80,0xa50dbf80,0x80003f80,0xa50dbf80,0xbf353f35,0x3f55bf0e,0xbf6d3ec4,0x3f7bbe48
    .long 0xbf80248d,0x3f6d3ec4,0xbf35bf35,0x3ec43f6d,0xbf35bf35,0x3e483f7b,0x3ec4bf6d,0xbf553f0e
    .long 0x80003f80,0x3f80a554,0xa50dbf80,0xbf80248d,0xbf353f35,0x3f0e3f55,0x3f6dbec4,0xbe48bf7b
    .long 0xbf80248d,0xbec43f6d,0x3f353f35,0x3f6dbec4,0xbf35bf35,0xbf7b3e48,0xbec43f6d,0x3f0e3f55
    .long 0x80003f80,0x80003f80,0x80003f80,0x80003f80,0xbf80248d,0xbf7bbe48,0xbf6dbec4,0xbf55bf0e
    .long 0xa50dbf80,0x3ec4bf6d,0x3f35bf35,0x3f6dbec4,0x3f80a554,0x3f553f0e,0x3ec43f6d,0xbe483f7b
    .long 0x80003f80,0xbf80248d,0xa50dbf80,0x3f80a554,0xbf80248d,0x3e48bf7b,0x3f6d3ec4,0xbf0e3f55
    .long 0xa50dbf80,0x3f6d3ec4,0xbf353f35,0xbec4bf6d,0x3f80a554,0xbf0e3f55,0xbec4bf6d,0x3f7b3e48
    .long 0x80003f80,0xa50dbf80,0x80003f80,0xa50dbf80,0xbf80248d,0x3f7b3e48,0xbf6dbec4,0x3f553f0e
    .long 0xa50dbf80,0xbec43f6d,0x3f35bf35,0xbf6d3ec4,0x3f80a554,0xbf55bf0e,0x3ec43f6d,0x3e48bf7b
    .long 0x80003f80,0x3f80a554,0xa50dbf80,0xbf80248d,0xbf80248d,0xbe483f7b,0x3f6d3ec4,0x3f0ebf55
    .long 0xa50dbf80,0xbf6dbec4,0xbf353f35,0x3ec43f6d,0x3f80a554,0x3f0ebf55,0xbec4bf6d,0xbf7bbe48
    .long 0x80003f80,0x80003f80,0x80003f80,0x80003f80,0xbf35bf35,0xbf0ebf55,0xbec4bf6d,0xbe48bf7b
    .long 0x3f80a554,0x3f6d3ec4,0x3f353f35,0x3ec43f6d,0xbf353f35,0xbf7b3e48,0xbf6dbec4,0xbf0ebf55
    .long 0x80003f80,0xbf80248d,0xa50dbf80,0x3f80a554,0xbf35bf35,0x3f55bf0e,0x3ec43f6d,0xbf7b3e48
    .long 0x3f80a554,0xbec43f6d,0xbf35bf35,0x3f6dbec4,0xbf353f35,0xbe48bf7b,0x3f6d3ec4,0xbf553f0e
    .long 0x80003f80,0xa50dbf80,0x80003f80,0xa50dbf80,0xbf35bf35,0x3f0e3f55,0xbec4bf6d,0x3e483f7b
    .long 0x3f80a554,0xbf6dbec4,0x3f353f35,0xbec4bf6d,0xbf353f35,0x3f7bbe48,0xbf6dbec4,0x3f0e3f55
    .long 0x80003f80,0x3f80a554,0xa50dbf80,0xbf80248d,0xbf35bf35,0xbf553f0e,0x3ec43f6d,0x3f7bbe48
    .long 0x3f80a554,0x3ec4bf6d,0xbf35bf35,0xbf6d3ec4,0xbf353f35,0x3e483f7b,0x3f6d3ec4,0x3f55bf0e
    .long 0x3f800000,0x3f800000,0x3f800000,0x3f800000,0x3f800000,0x3f7b3e48,0x3f6d3ec4,0x3f553f0e
    .long 0x3f800000,0x3f6d3ec4,0x3f353f35,0x3ec43f6d,0x3f800000,0x3f553f0e,0x3ec43f6d,0xbe483f7b
    .long 0x3f800000,0x248d3f80,0xbf80250d,0xa554bf80,0x3f800000,0xbe483f7b,0xbf6dbec4,0x3f0ebf55
    .long 0x3f800000,0xbec43f6d,0xbf35bf35,0x3f6dbec4,0x3f800000,0xbf0e3f55,0xbec4bf6d,0x3f7b3e48
    .long 0x3f800000,0xbf80250d,0x3f800000,0xbf80250d,0x3f800000,0xbf7bbe48,0x3f6d3ec4,0xbf55bf0e
    .long 0x3f800000,0xbf6dbec4,0x3f353f35,0xbec4bf6d,0x3f800000,0xbf55bf0e,0x3ec43f6d,0x3e48bf7b
    .long 0x3f800000,0xa554bf80,0xbf80250d,0x248d3f80,0x3f800000,0x3e48bf7b,0xbf6dbec4,0xbf0e3f55
    .long 0x3f800000,0x3ec4bf6d,0xbf35bf35,0xbf6d3ec4,0x3f800000,0x3f0ebf55,0xbec4bf6d,0xbf7bbe48
    .long 0x3f800000,0x3f800000,0x3f800000,0x3f800000,0x3f353f35,0x3f0e3f55,0x3ec43f6d,0x3e483f7b
    .long 0x248d3f80,0xbec43f6d,0xbf353f35,0xbf6d3ec4,0xbf353f35,0xbf7b3e48,0xbf6dbec4,0xbf0ebf55
    .long 0x3f800000,0x248d3f80,0xbf80250d,0xa554bf80,0x3f353f35,0xbf553f0e,0xbec4bf6d,0x3f7bbe48
    .long 0x248d3f80,0xbf6dbec4,0x3f35bf35,0x3ec43f6d,0xbf353f35,0xbe48bf7b,0x3f6d3ec4,0xbf553f0e
    .long 0x3f800000,0xbf80250d,0x3f800000,0xbf80250d,0x3f353f35,0xbf0ebf55,0x3ec43f6d,0xbe48bf7b
    .long 0x248d3f80,0x3ec4bf6d,0xbf353f35,0x3f6dbec4,0xbf353f35,0x3f7bbe48,0xbf6dbec4,0x3f0e3f55
    .long 0x3f800000,0xa554bf80,0xbf80250d,0x248d3f80,0x3f353f35,0x3f55bf0e,0xbec4bf6d,0xbf7b3e48
    .long 0x248d3f80,0x3f6d3ec4,0x3f35bf35,0xbec4bf6d,0xbf353f35,0x3e483f7b,0x3f6d3ec4,0x3f55bf0e
    .long 0x3f800000,0x3f800000,0x3f800000,0x3f800000,0x248d3f80,0xbe483f7b,0xbec43f6d,0xbf0e3f55
    .long 0xbf80250d,0xbf6dbec4,0xbf35bf35,0xbec4bf6d,0xa554bf80,0x3f0ebf55,0x3f6dbec4,0x3f7b3e48
    .long 0x3f800000,0x248d3f80,0xbf80250d,0xa554bf80,0x248d3f80,0xbf7bbe48,0x3ec4bf6d,0x3f553f0e
    .long 0xbf80250d,0x3ec4bf6d,0x3f353f35,0xbf6d3ec4,0xa554bf80,0x3f553f0e,0xbf6d3ec4,0x3e48bf7b
    .long 0x3f800000,0xbf80250d,0x3f800000,0xbf80250d,0x248d3f80,0x3e48bf7b,0xbec43f6d,0x3f0ebf55
    .long 0xbf80250d,0x3f6d3ec4,0xbf35bf35,0x3ec43f6d,0xa554bf80,0xbf0e3f55,0x3f6dbec4,0xbf7bbe48
    .long 0x3f800000,0xa554bf80,0xbf80250d,0x248d3f80,0x248d3f80,0x3f7b3e48,0x3ec4bf6d,0xbf55bf0e
    .long 0xbf80250d,0xbec43f6d,0x3f353f35,0x3f6dbec4,0xa554bf80,0xbf55bf0e,0xbf6d3ec4,0xbe483f7b
    .long 0x3f800000,0x3f800000,0x3f800000,0x3f800000,0xbf353f35,0xbf553f0e,0xbf6d3ec4,0xbf7b3e48
    .long 0xa554bf80,0x3ec4bf6d,0x3f35bf35,0x3f6dbec4,0x3f353f35,0x3e483f7b,0xbec43f6d,0xbf553f0e
    .long 0x3f800000,0x248d3f80,0xbf80250d,0xa554bf80,0xbf353f35,0xbf0ebf55,0x3f6dbec4,0x3e483f7b
    .long 0xa554bf80,0x3f6d3ec4,0xbf353f35,0xbec4bf6d,0x3f353f35,0xbf7b3e48,0x3ec4bf6d,0x3f0e3f55
    .long 0x3f800000,0xbf80250d,0x3f800000,0xbf80250d,0xbf353f35,0x3f55bf0e,0xbf6d3ec4,0x3f7bbe48
    .long 0xa554bf80,0xbec43f6d,0x3f35bf35,0xbf6d3ec4,0x3f353f35,0xbe48bf7b,0xbec43f6d,0x3f55bf0e
    .long 0x3f800000,0xa554bf80,0xbf80250d,0x248d3f80,0xbf353f35,0x3f0e3f55,0x3f6dbec4,0xbe48bf7b
    .long 0xa554bf80,0xbf6dbec4,0xbf353f35,0x3ec43f6d,0x3f353f35,0x3f7bbe48,0x3ec4bf6d,0xbf0ebf55
    .long 0x80003f80,0xbf353f35,0xbf80248d,0xbf35bf35,0x80003f80,0xbf553f0e,0xbf6dbec4,0xbe48bf7b
    .long 0x80003f80,0xbf6d3ec4,0xbf35bf35,0x3ec4bf6d,0x80003f80,0xbf7b3e48,0xbec4bf6d,0x3f55bf0e
    .long 0x80003f80,0xbf35bf35,0x3f80a554,0xbf353f35,0x80003f80,0xbf0ebf55,0x3f6d3ec4,0xbf7b3e48
    .long 0x80003f80,0xbec4bf6d,0x3f353f35,0xbf6dbec4,0x80003f80,0xbe48bf7b,0x3ec43f6d,0xbf0ebf55
    .long 0x80003f80,0x3f35bf35,0xbf80248d,0x3f353f35,0x80003f80,0x3f55bf0e,0xbf6dbec4,0x3e483f7b
    .long 0x80003f80,0x3f6dbec4,0xbf35bf35,0xbec43f6d,0x80003f80,0x3f7bbe48,0xbec4bf6d,0xbf553f0e
    .long 0x80003f80,0x3f353f35,0x3f80a554,0x3f35bf35,0x80003f80,0x3f0e3f55,0x3f6d3ec4,0x3f7bbe48
    .long 0x80003f80,0x3ec43f6d,0x3f353f35,0x3f6d3ec4,0x80003f80,0x3e483f7b,0x3ec43f6d,0x3f0e3f55
    .long 0xa50dbf80,0x3f35bf35,0x3f80a554,0x3f353f35,0x3f35bf35,0x3f7b3e48,0x3ec43f6d,0xbf0e3f55
    .long 0x3f80a554,0x3ec43f6d,0xbf353f35,0xbf6dbec4,0x3f353f35,0xbf0e3f55,0xbf6dbec4,0x3e48bf7b
    .long 0xa50dbf80,0x3f353f35,0xbf80248d,0x3f35bf35,0x3f35bf35,0xbe483f7b,0xbec4bf6d,0x3f553f0e
    .long 0x3f80a554,0xbf6d3ec4,0x3f35bf35,0xbec43f6d,0x3f353f35,0xbf55bf0e,0x3f6d3ec4,0xbf7bbe48
    .long 0xa50dbf80,0xbf353f35,0x3f80a554,0xbf35bf35,0x3f35bf35,0xbf7bbe48,0x3ec43f6d,0x3f0ebf55
    .long 0x3f80a554,0xbec4bf6d,0xbf353f35,0x3f6d3ec4,0x3f353f35,0x3f0ebf55,0xbf6dbec4,0xbe483f7b
    .long 0xa50dbf80,0xbf35bf35,0xbf80248d,0xbf353f35,0x3f35bf35,0x3e48bf7b,0xbec4bf6d,0xbf55bf0e
    .long 0x3f80a554,0x3f6dbec4,0x3f35bf35,0x3ec4bf6d,0x3f353f35,0x3f553f0e,0x3f6d3ec4,0x3f7b3e48
    .long 0x80003f80,0xbf353f35,0xbf80248d,0xbf35bf35,0xbf80248d,0xbf0ebf55,0x3ec4bf6d,0x3f7bbe48
    .long 0xa50dbf80,0x3f6dbec4,0x3f353f35,0xbec43f6d,0x3f80a554,0x3e483f7b,0xbf6d3ec4,0xbf0ebf55
    .long 0x80003f80,0xbf35bf35,0x3f80a554,0xbf353f35,0xbf80248d,0x3f55bf0e,0xbec43f6d,0xbe48bf7b
    .long 0xa50dbf80,0x3ec43f6d,0xbf35bf35,0x3f6d3ec4,0x3f80a554,0xbf7b3e48,0x3f6dbec4,0xbf553f0e
    .long 0x80003f80,0x3f35bf35,0xbf80248d,0x3f353f35,0xbf80248d,0x3f0e3f55,0x3ec4bf6d,0xbf7b3e48
    .long 0xa50dbf80,0xbf6d3ec4,0x3f353f35,0x3ec4bf6d,0x3f80a554,0xbe48bf7b,0xbf6d3ec4,0x3f0e3f55
    .long 0x80003f80,0x3f353f35,0x3f80a554,0x3f35bf35,0xbf80248d,0xbf553f0e,0xbec43f6d,0x3e483f7b
    .long 0xa50dbf80,0xbec4bf6d,0xbf35bf35,0xbf6dbec4,0x3f80a554,0x3f7bbe48,0x3f6dbec4,0x3f55bf0e
    .long 0xa50dbf80,0x3f35bf35,0x3f80a554,0x3f353f35,0x3f353f35,0xbe483f7b,0xbf6d3ec4,0xbf55bf0e
    .long 0xbf80248d,0xbec4bf6d,0x3f35bf35,0x3f6d3ec4,0x3f35bf35,0x3f553f0e,0xbec43f6d,0xbf7bbe48
    .long 0xa50dbf80,0x3f353f35,0xbf80248d,0x3f35bf35,0x3f353f35,0xbf7bbe48,0x3f6dbec4,0xbf0e3f55
    .long 0xbf80248d,0x3f6dbec4,0xbf353f35,0x3ec4bf6d,0x3f35bf35,0xbf0e3f55,0x3ec4bf6d,0xbe483f7b
    .long 0xa50dbf80,0xbf353f35,0x3f80a554,0xbf35bf35,0x3f353f35,0x3e48bf7b,0xbf6d3ec4,0x3f553f0e
    .long 0xbf80248d,0x3ec43f6d,0x3f35bf35,0xbf6dbec4,0x3f35bf35,0xbf55bf0e,0xbec43f6d,0x3f7b3e48
    .long 0xa50dbf80,0xbf35bf35,0xbf80248d,0xbf353f35,0x3f353f35,0x3f7b3e48,0x3f6dbec4,0x3f0ebf55
    .long 0xbf80248d,0xbf6d3ec4,0xbf353f35,0xbec43f6d,0x3f35bf35,0x3f0ebf55,0x3ec4bf6d,0x3e48bf7b
    .long 0x3f800000,0x3f353f35,0x248d3f80,0xbf353f35,0x3f800000,0x3f0e3f55,0xbec43f6d,0xbf7b3e48
    .long 0x3f800000,0x3ec43f6d,0xbf353f35,0xbf6dbec4,0x3f800000,0x3e483f7b,0xbf6d3ec4,0xbf0ebf55
    .long 0x3f800000,0xbf353f35,0xa554bf80,0x3f353f35,0x3f800000,0xbf553f0e,0x3ec4bf6d,0x3e483f7b
    .long 0x3f800000,0xbf6d3ec4,0x3f35bf35,0xbec43f6d,0x3f800000,0xbf7b3e48,0x3f6dbec4,0xbf553f0e
    .long 0x3f800000,0xbf35bf35,0x248d3f80,0x3f35bf35,0x3f800000,0xbf0ebf55,0xbec43f6d,0x3f7bbe48
    .long 0x3f800000,0xbec4bf6d,0xbf353f35,0x3f6d3ec4,0x3f800000,0xbe48bf7b,0xbf6d3ec4,0x3f0e3f55
    .long 0x3f800000,0x3f35bf35,0xa554bf80,0xbf35bf35,0x3f800000,0x3f55bf0e,0x3ec4bf6d,0xbe48bf7b
    .long 0x3f800000,0x3f6dbec4,0x3f35bf35,0x3ec4bf6d,0x3f800000,0x3f7bbe48,0x3f6dbec4,0x3f55bf0e
    .long 0xbf80250d,0xbf35bf35,0xa554bf80,0x3f35bf35,0xbf35bf35,0x3e48bf7b,0x3f6dbec4,0x3f553f0e
    .long 0xa554bf80,0x3f6dbec4,0x3f353f35,0xbec43f6d,0x3f35bf35,0x3f553f0e,0xbec43f6d,0xbf7bbe48
    .long 0xbf80250d,0x3f35bf35,0x248d3f80,0xbf35bf35,0xbf35bf35,0x3f7b3e48,0xbf6d3ec4,0x3f0ebf55
    .long 0xa554bf80,0x3ec43f6d,0xbf35bf35,0x3f6d3ec4,0x3f35bf35,0xbf0e3f55,0x3ec4bf6d,0xbe483f7b
    .long 0xbf80250d,0x3f353f35,0xa554bf80,0xbf353f35,0xbf35bf35,0xbe483f7b,0x3f6dbec4,0xbf55bf0e
    .long 0xa554bf80,0xbf6d3ec4,0x3f353f35,0x3ec4bf6d,0x3f35bf35,0xbf55bf0e,0xbec43f6d,0x3f7b3e48
    .long 0xbf80250d,0xbf353f35,0x248d3f80,0x3f353f35,0xbf35bf35,0xbf7bbe48,0xbf6d3ec4,0xbf0e3f55
    .long 0xa554bf80,0xbec4bf6d,0xbf35bf35,0xbf6dbec4,0x3f35bf35,0x3f0ebf55,0x3ec4bf6d,0x3e48bf7b
    .long 0x3f800000,0x3f353f35,0x248d3f80,0xbf353f35,0x248d3f80,0xbf553f0e,0xbf6dbec4,0xbe48bf7b
    .long 0xbf80250d,0xbec4bf6d,0x3f35bf35,0x3f6d3ec4,0xa554bf80,0x3f7bbe48,0x3ec43f6d,0xbf553f0e
    .long 0x3f800000,0xbf353f35,0xa554bf80,0x3f353f35,0x248d3f80,0xbf0ebf55,0x3f6d3ec4,0xbf7b3e48
    .long 0xbf80250d,0x3f6dbec4,0xbf353f35,0x3ec4bf6d,0xa554bf80,0x3e483f7b,0xbec4bf6d,0x3f0e3f55
    .long 0x3f800000,0xbf35bf35,0x248d3f80,0x3f35bf35,0x248d3f80,0x3f55bf0e,0xbf6dbec4,0x3e483f7b
    .long 0xbf80250d,0x3ec43f6d,0x3f35bf35,0xbf6dbec4,0xa554bf80,0xbf7b3e48,0x3ec43f6d,0x3f55bf0e
    .long 0x3f800000,0x3f35bf35,0xa554bf80,0xbf35bf35,0x248d3f80,0x3f0e3f55,0x3f6d3ec4,0x3f7bbe48
    .long 0xbf80250d,0xbf6d3ec4,0xbf353f35,0xbec43f6d,0xa554bf80,0xbe48bf7b,0xbec4bf6d,0xbf0ebf55
    .long 0xbf80250d,0xbf35bf35,0xa554bf80,0x3f35bf35,0x3f35bf35,0x3f7b3e48,0x3ec43f6d,0xbf0e3f55
    .long 0x248d3f80,0xbf6d3ec4,0xbf35bf35,0x3ec4bf6d,0xbf35bf35,0x3f0ebf55,0x3f6d3ec4,0xbe483f7b
    .long 0xbf80250d,0x3f35bf35,0x248d3f80,0xbf35bf35,0x3f35bf35,0xbe483f7b,0xbec4bf6d,0x3f553f0e
    .long 0x248d3f80,0xbec4bf6d,0x3f353f35,0xbf6dbec4,0xbf35bf35,0x3f553f0e,0xbf6dbec4,0x3f7b3e48
    .long 0xbf80250d,0x3f353f35,0xa554bf80,0xbf353f35,0x3f35bf35,0xbf7bbe48,0x3ec43f6d,0x3f0ebf55
    .long 0x248d3f80,0x3f6dbec4,0xbf35bf35,0xbec43f6d,0xbf35bf35,0xbf0e3f55,0x3f6d3ec4,0x3e48bf7b
    .long 0xbf80250d,0xbf353f35,0x248d3f80,0x3f353f35,0x3f35bf35,0x3e48bf7b,0xbec4bf6d,0xbf55bf0e
    .long 0x248d3f80,0x3ec43f6d,0x3f353f35,0x3f6d3ec4,0xbf35bf35,0xbf55bf0e,0xbf6dbec4,0xbf7bbe48
    .long 0x3f800000,0x0,0x3f800000,0x0,0x3f800000,0x0,0x3f7ffec4,0x3bc90f88
    .long 0x3f800000,0x0,0x3f7ffb11,0x3c490e90,0x3f800000,0x0,0x3f7ff4e6,0x3c96c9b6
    .long 0x3f800000,0x0,0x3f7fb10f,0x3d48fb30,0x3f800000,0x0,0x3f7f9c18,0x3d621469
    .long 0x3f800000,0x0,0x3f7f84ab,0x3d7b2b74,0x3f800000,0x0,0x3f7f6ac7,0x3d8a200a
    .long 0x3f800000,0x0,0x3f7ec46d,0x3dc8bd36,0x3f800000,0x0,0x3f7e9bc9,0x3dd53db9
    .long 0x3f800000,0x0,0x3f7e70b0,0x3de1bc2e,0x3f800000,0x0,0x3f7e4323,0x3dee3876
    .long 0x3f800000,0x0,0x3f7d3aac,0x3e164083,0x3f800000,0x0,0x3f7cfe73,0x3e1c76de
    .long 0x3f800000,0x0,0x3f7cbfc9,0x3e22abb6,0x3f800000,0x0,0x3f7c7eb0,0x3e28defc
    .long 0x3f800000,0x0,0x3f800000,0x0,0x3f7fec43,0x3cc90ab0,0x3f7fe129,0x3cfb49ba
    .long 0x3f7fb10f,0x3d48fb30,0x3f7f84ab,0x3d7b2b74,0x3f7f4e6d,0x3d96a905,0x3f7eea9d,0x3dbc3ac3
    .long 0x3f7b14be,0x3e47c5c2,0x3f7853f8,0x3e78cfcc,0x3f79c79d,0x3e605c13,0x3f764d97,0x3e8b9507
    .long 0x3f7853f8,0x3e78cfcc,0x3f740bdd,0x3e9aa086,0x3f76ba07,0x3e888e93,0x3f718f57,0x3ea986c4
    .long 0x3f6c835e,0x3ec3ef15,0x3f61c598,0x3ef15aea,0x3f6a09a7,0x3ecf7bca,0x3f5df6be,0x3eff17b2
    .long 0x3f676bd8,0x3edae880,0x3f59f26a,0x3f064b82,0x3f64aa59,0x3ee63375,0x3f55b993,0x3f0cead0
    .long 0x3f54db31,0x3f0e39da,0x3f3daef9,0x3f2beb4a,0x3f514d3d,0x3f13682a,0x3f385216,0x3f31a81d
    .long 0x3f4d9f02,0x3f187fc0,0x3f32c8c9,0x3f373a23,0x3f49d112,0x3f1d7fd1,0x3f2d1469,0x3f3ca003
    .long 0x3f800000,0x0,0x3f800000,0x0,0x3f7fb10f,0x3d48fb30,0x3f7f9c18,0x3d621469
    .long 0x3f7ec46d,0x3dc8bd36,0x3f7e70b0,0x3de1bc2e,0x3f7d3aac,0x3e164083,0x3f7c7eb0,0x3e28defc
    .long 0x3f6c835e,0x3ec3ef15,0x3f676bd8,0x3edae880,0x3f676bd8,0x3edae880,0x3f6106f2,0x3ef41f07
    .long 0x3f61c598,0x3ef15aea,0x3f59f26a,0x3f064b82,0x3f5b941a,0x3f039c3d,0x3f5233c6,0x3f121eb0
    .long 0x3f3504f3,0x3f3504f3,0x3f226799,0x3f45e403,0x3f2beb4a,0x3f3daef9,0x3f173c07,0x3f4e8d90
    .long 0x3f226799,0x3f45e403,0x3f0b9a6b,0x3f5695e5,0x3f187fc0,0x3f4d9f02,0x3eff17b2,0x3f5df6be
    .long 0x3ec3ef15,0x3f6c835e,0x3e78cfcc,0x3f7853f8,0x3eac7cd4,0x3f710908,0x3e419b37,0x3f7b61fc
    .long 0x3e94a031,0x3f74fa0b,0x3e09cf86,0x3f7dabcc,0x3e78cfcc,0x3f7853f8,0x3da3308c,0x3f7f2f9d
    .long 0x3f800000,0x0,0x3f800000,0x0,0x3f7f4e6d,0x3d96a905,0x3f7f2f9d,0x3da3308c
    .long 0x3f7d3aac,0x3e164083,0x3f7cbfc9,0x3e22abb6,0x3f79c79d,0x3e605c13,0x3f78b47b,0x3e72b651
    .long 0x3f54db31,0x3f0e39da,0x3f4d9f02,0x3f187fc0,0x3f49d112,0x3f1d7fd1,0x3f40d0da,0x3f286605
    .long 0x3f3daef9,0x3f2beb4a,0x3f32c8c9,0x3f373a23,0x3f3085bb,0x3f396842,0x3f239da9,0x3f44e3f5
    .long 0x3ec3ef15,0x3f6c835e,0x3e94a031,0x3f74fa0b,0x3ea09ae5,0x3f731447,0x3e5a3997,0x3f7a1e84
    .long 0x3e78cfcc,0x3f7853f8,0x3e09cf86,0x3f7dabcc,0x3e2f10a2,0x3f7c3b28,0x3d621469,0x3f7f9c18
    .long 0xbe47c5c2,0x3f7b14be,0xbeac7cd4,0x3f710908,0xbe888e93,0x3f76ba07,0xbed25a09,0x3f696591
    .long 0xbeac7cd4,0x3f710908,0xbef6e0cb,0x3f604621,0xbecf7bca,0x3f6a09a7,0xbf0cead0,0x3f55b993
    .long 0x3f800000,0x0,0x3f800000,0x0,0x3f7ffb11,0x3c490e90,0x3f7ff4e6,0x3c96c9b6
    .long 0x3f7fec43,0x3cc90ab0,0x3f7fd397,0x3d16c32c,0x3f7fd397,0x3d16c32c,0x3f7f9c18,0x3d621469
    .long 0x3f7ec46d,0x3dc8bd36,0x3f7d3aac,0x3e164083,0x3f7e70b0,0x3de1bc2e,0x3f7c7eb0,0x3e28defc
    .long 0x3f7e1324,0x3dfab273,0x3f7baccd,0x3e3b6ecf,0x3f7dabcc,0x3e09cf86,0x3f7ac516,0x3e4dee60
    .long 0x3f7b14be,0x3e47c5c2,0x3f74fa0b,0x3e94a031,0x3f7a7302,0x3e541501,0x3f73913f,0x3e9d9e78
    .long 0x3f79c79d,0x3e605c13,0x3f721352,0x3ea68f12,0x3f791298,0x3e6c9a7f,0x3f708066,0x3eaf713a
    .long 0x3f74fa0b,0x3e94a031,0x3f676bd8,0x3edae880,0x3f740bdd,0x3e9aa086,0x3f655e0b,0x3ee363fa
    .long 0x3f731447,0x3ea09ae5,0x3f633c5a,0x3eebcbbb,0x3f721352,0x3ea68f12,0x3f6106f2,0x3ef41f07
    .long 0x3f800000,0x0,0x3f800000,0x0,0x3f7fd397,0x3d16c32c,0x3f7fc38f,0x3d2fe007
    .long 0x3f7f4e6d,0x3d96a905,0x3f7f0e58,0x3dafb680,0x3f7e70b0,0x3de1bc2e,0x3f7de0b1,0x3e039502
    .long 0x3f74fa0b,0x3e94a031,0x3f710908,0x3eac7cd4,0x3f721352,0x3ea68f12,0x3f6d1c1d,0x3ec1071e
    .long 0x3f6ed89e,0x3eb8442a,0x3f68bf3c,0x3ed53641,0x3f6b4b0c,0x3ec9b953,0x3f63f473,0x3ee900b7
    .long 0x3f54db31,0x3f0e39da,0x3f45e403,0x3f226799,0x3f4f7a1f,0x3f15f6d9,0x3f3ebc1b,0x3f2ac082
    .long 0x3f49d112,0x3f1d7fd1,0x3f373a23,0x3f32c8c9,0x3f43e200,0x3f24d225,0x3f2f61a5,0x3f3a7ca4
    .long 0x3f226799,0x3f45e403,0x3f039c3d,0x3f5b941a,0x3f1b02c6,0x3f4bbbf8,0x3ef41f07,0x3f6106f2
    .long 0x3f13682a,0x3f514d3d,0x3ee0924f,0x3f660f88,0x3f0b9a6b,0x3f5695e5,0x3ecc9b8b,0x3f6aab7b
    .long 0x3f800000,0x0,0x3f800000,0x0,0x3f7f84ab,0x3d7b2b74,0x3f7f6ac7,0x3d8a200a
    .long 0x3f7e1324,0x3dfab273,0x3f7dabcc,0x3e09cf86,0x3f7baccd,0x3e3b6ecf,0x3f7ac516,0x3e4dee60
    .long 0x3f61c598,0x3ef15aea,0x3f5b941a,0x3f039c3d,0x3f59f26a,0x3f064b82,0x3f5233c6,0x3f121eb0
    .long 0x3f514d3d,0x3f13682a,0x3f47de65,0x3f1ff6cb,0x3f47de65,0x3f1ff6cb,0x3f3ca003,0x3f2d1469
    .long 0x3f0e39da,0x3f54db31,0x3ef15aea,0x3f61c598,0x3f00e7e4,0x3f5d2d53,0x3ed25a09,0x3f696591
    .long 0x3ee63375,0x3f64aa59,0x3eb263ef,0x3f6ff573,0x3ec9b953,0x3f6b4b0c,0x3e919ddd,0x3f756d97
    .long 0x3dc8bd36,0x3f7ec46d,0xbd48fb30,0x3f7fb10f,0x3d16c32c,0x3f7fd397,0xbdee3876,0x3f7e4323
    .long 0xbcc90ab0,0x3f7fec43,0xbe3b6ecf,0x3f7baccd,0xbdafb680,0x3f7f0e58,0xbe7ee6e1,0x3f77f110
    .long 0x3f800000,0x0,0x3f800000,0x0,0x3f7f0e58,0x3dafb680,0x3f7eea9d,0x3dbc3ac3
    .long 0x3f7c3b28,0x3e2f10a2,0x3f7baccd,0x3e3b6ecf,0x3f778bc5,0x3e827dc0,0x3f764d97,0x3e8b9507
    .long 0x3f45e403,0x3f226799,0x3f3daef9,0x3f2beb4a,0x3f373a23,0x3f32c8c9,0x3f2d1469,0x3f3ca003
    .long 0x3f273656,0x3f41d870,0x3f1b02c6,0x3f4bbbf8,0x3f15f6d9,0x3f4f7a1f,0x3f07a136,0x3f591e6a
    .long 0x3e47c5c2,0x3f7b14be,0x3dc8bd36,0x3f7ec46d,0x3de1bc2e,0x3f7e70b0,0x3bc90f88,0x3f7ffec4
    .long 0x3cc90ab0,0x3f7fec43,0xbdafb680,0x3f7f0e58,0xbd7b2b74,0x3f7f84ab,0xbe354098,0x3f7bf531
    .long 0xbef15aea,0x3f61c598,0xbf187fc0,0x3f4d9f02,0xbf0b9a6b,0x3f5695e5,0xbf2ac082,0x3f3ebc1b
    .long 0xbf1d7fd1,0x3f49d112,0xbf3b8f3b,0x3f2e3bde,0xbf2e3bde,0x3f3b8f3b,0xbf4ac77f,0x3f1c420c
    .long 0x3f800000,0x0,0x3f7fec43,0x3cc90ab0,0x3f800000,0x0,0x3f7fe129,0x3cfb49ba
    .long 0x3f800000,0x0,0x3f7fd397,0x3d16c32c,0x3f800000,0x0,0x3f7fc38f,0x3d2fe007
    .long 0x3f800000,0x0,0x3f7f4e6d,0x3d96a905,0x3f800000,0x0,0x3f7f2f9d,0x3da3308c
    .long 0x3f800000,0x0,0x3f7f0e58,0x3dafb680,0x3f800000,0x0,0x3f7eea9d,0x3dbc3ac3
    .long 0x3f800000,0x0,0x3f7e1324,0x3dfab273,0x3f800000,0x0,0x3f7de0b1,0x3e039502
    .long 0x3f800000,0x0,0x3f7dabcc,0x3e09cf86,0x3f800000,0x0,0x3f7d7474,0x3e1008b7
    .long 0x3f800000,0x0,0x3f7c3b28,0x3e2f10a2,0x3f800000,0x0,0x3f7bf531,0x3e354098
    .long 0x3f800000,0x0,0x3f7baccd,0x3e3b6ecf,0x3f800000,0x0,0x3f7b61fc,0x3e419b37
    .long 0x3f7ec46d,0x3dc8bd36,0x3f7e1324,0x3dfab273,0x3f7e1324,0x3dfab273,0x3f7cfe73,0x3e1c76de
    .long 0x3f7d3aac,0x3e164083,0x3f7baccd,0x3e3b6ecf,0x3f7c3b28,0x3e2f10a2,0x3f7a1e84,0x3e5a3997
    .long 0x3f74fa0b,0x3e94a031,0x3f6ed89e,0x3eb8442a,0x3f731447,0x3ea09ae5,0x3f6be858,0x3ec6d529
    .long 0x3f710908,0x3eac7cd4,0x3f68bf3c,0x3ed53641,0x3f6ed89e,0x3eb8442a,0x3f655e0b,0x3ee363fa
    .long 0x3f61c598,0x3ef15aea,0x3f514d3d,0x3f13682a,0x3f5ebe05,0x3efc5d27,0x3f4cae79,0x3f19c200
    .long 0x3f5b941a,0x3f039c3d,0x3f47de65,0x3f1ff6cb,0x3f584853,0x3f08f59b,0x3f42de29,0x3f26050a
    .long 0x3f45e403,0x3f226799,0x3f273656,0x3f41d870,0x3f41d870,0x3f273656,0x3f212ff9,0x3f46e22a
    .long 0x3f3daef9,0x3f2beb4a,0x3f1b02c6,0x3f4bbbf8,0x3f396842,0x3f3085bb,0x3f14b039,0x3f5064af
    .long 0x3f7b14be,0x3e47c5c2,0x3f79c79d,0x3e605c13,0x3f7853f8,0x3e78cfcc,0x3f764d97,0x3e8b9507
    .long 0x3f74fa0b,0x3e94a031,0x3f721352,0x3ea68f12,0x3f710908,0x3eac7cd4,0x3f6d1c1d,0x3ec1071e
    .long 0x3f54db31,0x3f0e39da,0x3f49d112,0x3f1d7fd1,0x3f4d9f02,0x3f187fc0,0x3f40d0da,0x3f286605
    .long 0x3f45e403,0x3f226799,0x3f373a23,0x3f32c8c9,0x3f3daef9,0x3f2beb4a,0x3f2d1469,0x3f3ca003
    .long 0x3f0e39da,0x3f54db31,0x3ee63375,0x3f64aa59,0x3f039c3d,0x3f5b941a,0x3ecc9b8b,0x3f6aab7b
    .long 0x3ef15aea,0x3f61c598,0x3eb263ef,0x3f6ff573,0x3edae880,0x3f676bd8,0x3e97a117,0x3f748422
    .long 0x3e47c5c2,0x3f7b14be,0x3cc90ab0,0x3f7fec43,0x3e164083,0x3f7d3aac,0xbcfb49ba,0x3f7fe129
    .long 0x3dc8bd36,0x3f7ec46d,0xbdafb680,0x3f7f0e58,0x3d48fb30,0x3f7fb10f,0xbe1008b7,0x3f7d7474
    .long 0x3f74fa0b,0x3e94a031,0x3f731447,0x3ea09ae5,0x3f6ed89e,0x3eb8442a,0x3f6be858,0x3ec6d529
    .long 0x3f676bd8,0x3edae880,0x3f633c5a,0x3eebcbbb,0x3f5ebe05,0x3efc5d27,0x3f591e6a,0x3f07a136
    .long 0x3f226799,0x3f45e403,0x3f13682a,0x3f514d3d,0x3f13682a,0x3f514d3d,0x3f0242b1,0x3f5c61c7
    .long 0x3f039c3d,0x3f5b941a,0x3ee0924f,0x3f660f88,0x3ee63375,0x3f64aa59,0x3ebb31a0,0x3f6e46be
    .long 0x3dc8bd36,0x3f7ec46d,0xbcc90ab0,0x3f7fec43,0x3cc90ab0,0x3f7fec43,0xbdd53db9,0x3f7e9bc9
    .long 0xbd48fb30,0x3f7fb10f,0xbe3b6ecf,0x3f7baccd,0xbdfab273,0x3f7e1324,0xbe8586ce,0x3f772417
    .long 0xbef15aea,0x3f61c598,0xbf1d7fd1,0x3f49d112,0xbf08f59b,0x3f584853,0xbf2d1469,0x3f3ca003
    .long 0xbf187fc0,0x3f4d9f02,0xbf3b8f3b,0x3f2e3bde,0xbf273656,0x3f41d870,0xbf48d8b3,0x3f1ebc12
    .long 0x3f7fb10f,0x3d48fb30,0x3f7f4e6d,0x3d96a905,0x3f7f84ab,0x3d7b2b74,0x3f7eea9d,0x3dbc3ac3
    .long 0x3f7f4e6d,0x3d96a905,0x3f7e70b0,0x3de1bc2e,0x3f7f0e58,0x3dafb680,0x3f7de0b1,0x3e039502
    .long 0x3f7d3aac,0x3e164083,0x3f79c79d,0x3e605c13,0x3f7cbfc9,0x3e22abb6,0x3f78b47b,0x3e72b651
    .long 0x3f7c3b28,0x3e2f10a2,0x3f778bc5,0x3e827dc0,0x3f7baccd,0x3e3b6ecf,0x3f764d97,0x3e8b9507
    .long 0x3f7853f8,0x3e78cfcc,0x3f6ed89e,0x3eb8442a,0x3f778bc5,0x3e827dc0,0x3f6d1c1d,0x3ec1071e
    .long 0x3f76ba07,0x3e888e93,0x3f6b4b0c,0x3ec9b953,0x3f75dec6,0x3e8e9a22,0x3f696591,0x3ed25a09
    .long 0x3f710908,0x3eac7cd4,0x3f5ebe05,0x3efc5d27,0x3f6ff573,0x3eb263ef,0x3f5c61c7,0x3f0242b1
    .long 0x3f6ed89e,0x3eb8442a,0x3f59f26a,0x3f064b82,0x3f6db293,0x3ebe1d4a,0x3f577026,0x3f0a48ad
    .long 0x3f7d3aac,0x3e164083,0x3f7c3b28,0x3e2f10a2,0x3f7baccd,0x3e3b6ecf,0x3f7a1e84,0x3e5a3997
    .long 0x3f79c79d,0x3e605c13,0x3f778bc5,0x3e827dc0,0x3f778bc5,0x3e827dc0,0x3f748422,0x3e97a117
    .long 0x3f676bd8,0x3edae880,0x3f5ebe05,0x3efc5d27,0x3f633c5a,0x3eebcbbb,0x3f591e6a,0x3f07a136
    .long 0x3f5ebe05,0x3efc5d27,0x3f531849,0x3f10d3cd,0x3f59f26a,0x3f064b82,0x3f4cae79,0x3f19c200
    .long 0x3f3daef9,0x3f2beb4a,0x3f273656,0x3f41d870,0x3f373a23,0x3f32c8c9,0x3f1ebc12,0x3f48d8b3
    .long 0x3f3085bb,0x3f396842,0x3f15f6d9,0x3f4f7a1f,0x3f299415,0x3f3fc767,0x3f0cead0,0x3f55b993
    .long 0x3f039c3d,0x3f5b941a,0x3eb8442a,0x3f6ed89e,0x3ef6e0cb,0x3f604621,0x3ea395c5,0x3f7294f8
    .long 0x3ee63375,0x3f64aa59,0x3e8e9a22,0x3f75dec6,0x3ed53641,0x3f68bf3c,0x3e72b651,0x3f78b47b
    .long 0x3f7853f8,0x3e78cfcc,0x3f76ba07,0x3e888e93,0x3f740bdd,0x3e9aa086,0x3f718f57,0x3ea986c4
    .long 0x3f6ed89e,0x3eb8442a,0x3f6b4b0c,0x3ec9b953,0x3f68bf3c,0x3ed53641,0x3f63f473,0x3ee900b7
    .long 0x3f3daef9,0x3f2beb4a,0x3f3085bb,0x3f396842,0x3f32c8c9,0x3f373a23,0x3f239da9,0x3f44e3f5
    .long 0x3f273656,0x3f41d870,0x3f15f6d9,0x3f4f7a1f,0x3f1b02c6,0x3f4bbbf8,0x3f07a136,0x3f591e6a
    .long 0x3eac7cd4,0x3f710908,0x3e605c13,0x3f79c79d,0x3e8e9a22,0x3f75dec6,0x3e1c76de,0x3f7cfe73
    .long 0x3e605c13,0x3f79c79d,0x3dafb680,0x3f7f0e58,0x3e22abb6,0x3f7cbfc9,0x3c96c9b6,0x3f7ff4e6
    .long 0xbe164083,0x3f7d3aac,0xbea09ae5,0x3f731447,0xbe541501,0x3f7a7302,0xbec1071e,0x3f6d1c1d
    .long 0xbe888e93,0x3f76ba07,0xbee0924f,0x3f660f88,0xbea68f12,0x3f721352,0xbeff17b2,0x3f5df6be
    .long 0x3f710908,0x3eac7cd4,0x3f6ed89e,0x3eb8442a,0x3f68bf3c,0x3ed53641,0x3f655e0b,0x3ee363fa
    .long 0x3f5ebe05,0x3efc5d27,0x3f59f26a,0x3f064b82,0x3f531849,0x3f10d3cd,0x3f4cae79,0x3f19c200
    .long 0x3f039c3d,0x3f5b941a,0x3ee63375,0x3f64aa59,0x3ee0924f,0x3f660f88,0x3ebb31a0,0x3f6e46be
    .long 0x3eb8442a,0x3f6ed89e,0x3e8e9a22,0x3f75dec6,0x3e8e9a22,0x3f75dec6,0x3e419b37,0x3f7b61fc
    .long 0xbe164083,0x3f7d3aac,0xbe888e93,0x3f76ba07,0xbe6c9a7f,0x3f791298,0xbeb554ec,0x3f6f6830
    .long 0xbea09ae5,0x3f731447,0xbee0924f,0x3f660f88,0xbec9b953,0x3f6b4b0c,0xbf04f484,0x3f5ac450
    .long 0xbf3daef9,0x3f2beb4a,0xbf584853,0x3f08f59b,0xbf4bbbf8,0x3f1b02c6,0xbf63f473,0x3ee900b7
    .long 0xbf584853,0x3f08f59b,0xbf6db293,0x3ebe1d4a,0xbf633c5a,0x3eebcbbb,0xbf756d97,0x3e919ddd
    .long 0x3f800000,0x0,0x3f800000,0x0,0x3f7ec46d,0x3dc8bd36,0x3f7e9bc9,0x3dd53db9
    .long 0x3f7b14be,0x3e47c5c2,0x3f7a7302,0x3e541501,0x3f74fa0b,0x3e94a031,0x3f73913f,0x3e9d9e78
    .long 0x3f3504f3,0x3f3504f3,0x3f2beb4a,0x3f3daef9,0x3f226799,0x3f45e403,0x3f173c07,0x3f4e8d90
    .long 0x3f0e39da,0x3f54db31,0x3f00e7e4,0x3f5d2d53,0x3ef15aea,0x3f61c598,0x3ed25a09,0x3f696591
    .long 0x248d3132,0x3f800000,0xbdc8bd36,0x3f7ec46d,0xbdc8bd36,0x3f7ec46d,0xbe4dee60,0x3f7ac516
    .long 0xbe47c5c2,0x3f7b14be,0xbe9aa086,0x3f740bdd,0xbe94a031,0x3f74fa0b,0xbecc9b8b,0x3f6aab7b
    .long 0xbf3504f3,0x3f3504f3,0xbf4d9f02,0x3f187fc0,0xbf45e403,0x3f226799,0xbf5c61c7,0x3f0242b1
    .long 0xbf54db31,0x3f0e39da,0xbf68bf3c,0x3ed53641,0xbf61c598,0x3ef15aea,0xbf7294f8,0x3ea395c5
    .long 0x3f800000,0x0,0x3f800000,0x0,0x3f7e1324,0x3dfab273,0x3f7de0b1,0x3e039502
    .long 0x3f7853f8,0x3e78cfcc,0x3f778bc5,0x3e827dc0,0x3f6ed89e,0x3eb8442a,0x3f6d1c1d,0x3ec1071e
    .long 0x3f0e39da,0x3f54db31,0x3f039c3d,0x3f5b941a,0x3ee63375,0x3f64aa59,0x3ecc9b8b,0x3f6aab7b
    .long 0x3eac7cd4,0x3f710908,0x3e8e9a22,0x3f75dec6,0x3e605c13,0x3f79c79d,0x3e1c76de,0x3f7cfe73
    .long 0xbec3ef15,0x3f6c835e,0xbef15aea,0x3f61c598,0xbefc5d27,0x3f5ebe05,0xbf14b039,0x3f5064af
    .long 0xbf187fc0,0x3f4d9f02,0xbf2e3bde,0x3f3b8f3b,0xbf3085bb,0x3f396842,0xbf44e3f5,0x3f239da9
    .long 0xbf7b14be,0x3e47c5c2,0xbf7fb10f,0x3d48fb30,0xbf7f4e6d,0x3d96a905,0xbf7f2f9d,0xbda3308c
    .long 0xbf7fb10f,0xbd48fb30,0xbf7a7302,0xbe541501,0xbf7c3b28,0xbe2f10a2,0xbf718f57,0xbea986c4
    .long 0x3f800000,0x0,0x3f800000,0x0,0x3f7d3aac,0x3e164083,0x3f7cfe73,0x3e1c76de
    .long 0x3f74fa0b,0x3e94a031,0x3f740bdd,0x3e9aa086,0x3f676bd8,0x3edae880,0x3f655e0b,0x3ee363fa
    .long 0x3ec3ef15,0x3f6c835e,0x3eac7cd4,0x3f710908,0x3e78cfcc,0x3f7853f8,0x3e419b37,0x3f7b61fc
    .long 0x3dc8bd36,0x3f7ec46d,0x3d16c32c,0x3f7fd397,0xbd48fb30,0x3f7fb10f,0xbdee3876,0x3f7e4323
    .long 0xbf3504f3,0x3f3504f3,0xbf45e403,0x3f226799,0xbf4d9f02,0x3f187fc0,0xbf5c61c7,0x3f0242b1
    .long 0xbf61c598,0x3ef15aea,0xbf6db293,0x3ebe1d4a,0xbf710908,0x3eac7cd4,0xbf796e4e,0x3e667c66
    .long 0xbf6c835e,0xbec3ef15,0xbf5b941a,0xbf039c3d,0xbf5b941a,0xbf039c3d,0xbf44e3f5,0xbf239da9
    .long 0xbf45e403,0xbf226799,0xbf299415,0xbf3fc767,0xbf2beb4a,0xbf3daef9,0xbf0a48ad,0xbf577026
    .long 0x3f800000,0x0,0x3f800000,0x0,0x3f7c3b28,0x3e2f10a2,0x3f7bf531,0x3e354098
    .long 0x3f710908,0x3eac7cd4,0x3f6ff573,0x3eb263ef,0x3f5ebe05,0x3efc5d27,0x3f5c61c7,0x3f0242b1
    .long 0x3e47c5c2,0x3f7b14be,0x3e164083,0x3f7d3aac,0x3cc90ab0,0x3f7fec43,0xbcfb49ba,0x3f7fe129
    .long 0xbe164083,0x3f7d3aac,0xbe541501,0x3f7a7302,0xbea09ae5,0x3f731447,0xbec1071e,0x3f6d1c1d
    .long 0xbf6c835e,0x3ec3ef15,0xbf74fa0b,0x3e94a031,0xbf79c79d,0x3e605c13,0xbf7e4323,0x3dee3876
    .long 0xbf7fb10f,0x3d48fb30,0xbf7f84ab,0xbd7b2b74,0xbf7e1324,0xbdfab273,0xbf78b47b,0xbe72b651
    .long 0xbf0e39da,0xbf54db31,0xbedae880,0xbf676bd8,0xbecf7bca,0xbf6a09a7,0xbe8586ce,0xbf772417
    .long 0xbe78cfcc,0xbf7853f8,0xbdafb680,0xbf7f0e58,0xbd96a905,0xbf7f4e6d,0x3dbc3ac3,0xbf7eea9d
    .long 0x3f800000,0x0,0x3f800000,0x0,0x3f7e70b0,0x3de1bc2e,0x3f7e4323,0x3dee3876
    .long 0x3f79c79d,0x3e605c13,0x3f791298,0x3e6c9a7f,0x3f721352,0x3ea68f12,0x3f708066,0x3eaf713a
    .long 0x3f226799,0x3f45e403,0x3f187fc0,0x3f4d9f02,0x3f0b9a6b,0x3f5695e5,0x3eff17b2,0x3f5df6be
    .long 0x3ee63375,0x3f64aa59,0x3ec9b953,0x3f6b4b0c,0x3eb263ef,0x3f6ff573,0x3e919ddd,0x3f756d97
    .long 0xbe47c5c2,0x3f7b14be,0xbe94a031,0x3f74fa0b,0xbe9aa086,0x3f740bdd,0xbecc9b8b,0x3f6aab7b
    .long 0xbecf7bca,0x3f6a09a7,0xbf00e7e4,0x3f5d2d53,0xbf00e7e4,0x3f5d2d53,0xbf19c200,0x3f4cae79
    .long 0xbf61c598,0x3ef15aea,0xbf710908,0x3eac7cd4,0xbf6db293,0x3ebe1d4a,0xbf796e4e,0x3e667c66
    .long 0xbf76ba07,0x3e888e93,0xbf7e70b0,0x3de1bc2e,0xbf7cbfc9,0x3e22abb6,0xbf7ffec4,0xbbc90f88
    .long 0x3f800000,0x0,0x3f800000,0x0,0x3f7dabcc,0x3e09cf86,0x3f7d7474,0x3e1008b7
    .long 0x3f76ba07,0x3e888e93,0x3f75dec6,0x3e8e9a22,0x3f6b4b0c,0x3ec9b953,0x3f696591,0x3ed25a09
    .long 0x3ef15aea,0x3f61c598,0x3edae880,0x3f676bd8,0x3eb263ef,0x3f6ff573,0x3e97a117,0x3f748422
    .long 0x3e605c13,0x3f79c79d,0x3e22abb6,0x3f7cbfc9,0x3dafb680,0x3f7f0e58,0x3c96c9b6,0x3f7ff4e6
    .long 0xbf0e39da,0x3f54db31,0xbf226799,0x3f45e403,0xbf299415,0x3f3fc767,0xbf3ca003,0x3f2d1469
    .long 0xbf41d870,0x3f273656,0xbf531849,0x3f10d3cd,0xbf5695e5,0x3f0b9a6b,0xbf655e0b,0x3ee363fa
    .long 0xbf7ec46d,0xbdc8bd36,0xbf7853f8,0xbe78cfcc,0xbf791298,0xbe6c9a7f,0xbf6d1c1d,0xbec1071e
    .long 0xbf6ed89e,0xbeb8442a,0xbf5d2d53,0xbf00e7e4,0xbf604621,0xbef6e0cb,0xbf48d8b3,0xbf1ebc12
    .long 0x3f800000,0x0,0x3f800000,0x0,0x3f7cbfc9,0x3e22abb6,0x3f7c7eb0,0x3e28defc
    .long 0x3f731447,0x3ea09ae5,0x3f721352,0x3ea68f12,0x3f633c5a,0x3eebcbbb,0x3f6106f2,0x3ef41f07
    .long 0x3e94a031,0x3f74fa0b,0x3e78cfcc,0x3f7853f8,0x3e09cf86,0x3f7dabcc,0x3da3308c,0x3f7f2f9d
    .long 0xbcc90ab0,0x3f7fec43,0xbdafb680,0x3f7f0e58,0xbe3b6ecf,0x3f7baccd,0xbe7ee6e1,0x3f77f110
    .long 0xbf54db31,0x3f0e39da,0xbf61c598,0x3ef15aea,0xbf68bf3c,0x3ed53641,0xbf7294f8,0x3ea395c5
    .long 0xbf76ba07,0x3e888e93,0xbf7cbfc9,0x3e22abb6,0xbf7e70b0,0x3de1bc2e,0xbf7ffec4,0xbbc90f88
    .long 0xbf45e403,0xbf226799,0xbf2beb4a,0xbf3daef9,0xbf299415,0xbf3fc767,0xbf0a48ad,0xbf577026
    .long 0xbf08f59b,0xbf584853,0xbec9b953,0xbf6b4b0c,0xbec9b953,0xbf6b4b0c,0xbe72b651,0xbf78b47b
    .long 0x3f800000,0x0,0x3f800000,0x0,0x3f7baccd,0x3e3b6ecf,0x3f7b61fc,0x3e419b37
    .long 0x3f6ed89e,0x3eb8442a,0x3f6db293,0x3ebe1d4a,0x3f59f26a,0x3f064b82,0x3f577026,0x3f0a48ad
    .long 0x3dc8bd36,0x3f7ec46d,0x3d48fb30,0x3f7fb10f,0xbdafb680,0x3f7f0e58,0xbe1008b7,0x3f7d7474
    .long 0xbe888e93,0x3f76ba07,0xbea68f12,0x3f721352,0xbee0924f,0x3f660f88,0xbeff17b2,0x3f5df6be
    .long 0xbf7b14be,0x3e47c5c2,0xbf7ec46d,0x3dc8bd36,0xbf7ffb11,0x3c490e90,0xbf7eea9d,0xbdbc3ac3
    .long 0xbf7c3b28,0xbe2f10a2,0xbf75dec6,0xbe8e9a22,0xbf6ff573,0xbeb263ef,0xbf63f473,0xbee900b7
    .long 0xbe94a031,0xbf74fa0b,0xbe164083,0xbf7d3aac,0xbde1bc2e,0xbf7e70b0,0x3d2fe007,0xbf7fc38f
    .long 0x3d96a905,0xbf7f4e6d,0x3e6c9a7f,0xbf791298,0x3e827dc0,0xbf778bc5,0x3ed25a09,0xbf696591
    .long 0x3f6c835e,0x3ec3ef15,0x3f6a09a7,0x3ecf7bca,0x3f61c598,0x3ef15aea,0x3f5df6be,0x3eff17b2
    .long 0x3f54db31,0x3f0e39da,0x3f4f7a1f,0x3f15f6d9,0x3f45e403,0x3f226799,0x3f3ebc1b,0x3f2ac082
    .long 0x3ec3ef15,0x3f6c835e,0x3ea09ae5,0x3f731447,0x3e94a031,0x3f74fa0b,0x3e5a3997,0x3f7a1e84
    .long 0x3e47c5c2,0x3f7b14be,0x3de1bc2e,0x3f7e70b0,0x3dc8bd36,0x3f7ec46d,0x3bc90f88,0x3f7ffec4
    .long 0xbec3ef15,0x3f6c835e,0xbefc5d27,0x3f5ebe05,0xbef15aea,0x3f61c598,0xbf14b039,0x3f5064af
    .long 0xbf0e39da,0x3f54db31,0xbf299415,0x3f3fc767,0xbf226799,0x3f45e403,0xbf3ca003,0x3f2d1469
    .long 0xbf6c835e,0x3ec3ef15,0xbf79c79d,0x3e605c13,0xbf74fa0b,0x3e94a031,0xbf7e4323,0x3dee3876
    .long 0xbf7b14be,0x3e47c5c2,0xbf7ffb11,0x3c490e90,0xbf7ec46d,0x3dc8bd36,0xbf7eea9d,0xbdbc3ac3
    .long 0x3f61c598,0x3ef15aea,0x3f5ebe05,0x3efc5d27,0x3f514d3d,0x3f13682a,0x3f4cae79,0x3f19c200
    .long 0x3f3daef9,0x3f2beb4a,0x3f373a23,0x3f32c8c9,0x3f273656,0x3f41d870,0x3f1ebc12,0x3f48d8b3
    .long 0x3dc8bd36,0x3f7ec46d,0x3cc90ab0,0x3f7fec43,0xbcc90ab0,0x3f7fec43,0xbdd53db9,0x3f7e9bc9
    .long 0xbe164083,0x3f7d3aac,0xbe6c9a7f,0x3f791298,0xbe888e93,0x3f76ba07,0xbeb554ec,0x3f6f6830
    .long 0xbf45e403,0x3f226799,0xbf584853,0x3f08f59b,0xbf584853,0x3f08f59b,0xbf6816a8,0x3ed8106b
    .long 0xbf676bd8,0x3edae880,0xbf740bdd,0x3e9aa086,0xbf731447,0x3ea09ae5,0xbf7bf531,0x3e354098
    .long 0xbf74fa0b,0xbe94a031,0xbf64aa59,0xbee63375,0xbf6a09a7,0xbecf7bca,0xbf53fac3,0xbf0f8784
    .long 0xbf5b941a,0xbf039c3d,0xbf3fc767,0xbf299415,0xbf49d112,0xbf1d7fd1,0xbf286605,0xbf40d0da
    .long 0x3f54db31,0x3f0e39da,0x3f514d3d,0x3f13682a,0x3f3daef9,0x3f2beb4a,0x3f385216,0x3f31a81d
    .long 0x3f226799,0x3f45e403,0x3f1b02c6,0x3f4bbbf8,0x3f039c3d,0x3f5b941a,0x3ef41f07,0x3f6106f2
    .long 0xbe47c5c2,0x3f7b14be,0xbe888e93,0x3f76ba07,0xbeac7cd4,0x3f710908,0xbed25a09,0x3f696591
    .long 0xbef15aea,0x3f61c598,0xbf0b9a6b,0x3f5695e5,0xbf187fc0,0x3f4d9f02,0xbf2ac082,0x3f3ebc1b
    .long 0xbf7b14be,0x3e47c5c2,0xbf7f4e6d,0x3d96a905,0xbf7fb10f,0x3d48fb30,0xbf7f2f9d,0xbda3308c
    .long 0xbf7ec46d,0xbdc8bd36,0xbf791298,0xbe6c9a7f,0xbf7853f8,0xbe78cfcc,0xbf6d1c1d,0xbec1071e
    .long 0xbf0e39da,0xbf54db31,0xbecf7bca,0xbf6a09a7,0xbedae880,0xbf676bd8,0xbe8586ce,0xbf772417
    .long 0xbe94a031,0xbf74fa0b,0xbde1bc2e,0xbf7e70b0,0xbe164083,0xbf7d3aac,0x3d2fe007,0xbf7fc38f
    .long 0x3f45e403,0x3f226799,0x3f41d870,0x3f273656,0x3f273656,0x3f41d870,0x3f212ff9,0x3f46e22a
    .long 0x3f039c3d,0x3f5b941a,0x3ef6e0cb,0x3f604621,0x3eb8442a,0x3f6ed89e,0x3ea395c5,0x3f7294f8
    .long 0xbef15aea,0x3f61c598,0xbf08f59b,0x3f584853,0xbf1d7fd1,0x3f49d112,0xbf2d1469,0x3f3ca003
    .long 0xbf3daef9,0x3f2beb4a,0xbf4bbbf8,0x3f1b02c6,0xbf584853,0x3f08f59b,0xbf63f473,0x3ee900b7
    .long 0xbf74fa0b,0xbe94a031,0xbf6a09a7,0xbecf7bca,0xbf64aa59,0xbee63375,0xbf53fac3,0xbf0f8784
    .long 0xbf4d9f02,0xbf187fc0,0xbf373a23,0xbf32c8c9,0xbf3085bb,0xbf396842,0xbf14b039,0xbf5064af
    .long 0x3dc8bd36,0xbf7ec46d,0x3e888e93,0xbf76ba07,0x3e888e93,0xbf76ba07,0x3eddbe79,0xbf66becc
    .long 0x3edae880,0xbf676bd8,0x3f15f6d9,0xbf4f7a1f,0x3f13682a,0xbf514d3d,0x3f385216,0xbf31a81d
    .long 0x3f676bd8,0x3edae880,0x3f64aa59,0x3ee63375,0x3f59f26a,0x3f064b82,0x3f55b993,0x3f0cead0
    .long 0x3f49d112,0x3f1d7fd1,0x3f43e200,0x3f24d225,0x3f373a23,0x3f32c8c9,0x3f2f61a5,0x3f3a7ca4
    .long 0x3e78cfcc,0x3f7853f8,0x3e2f10a2,0x3f7c3b28,0x3e09cf86,0x3f7dabcc,0x3d621469,0x3f7f9c18
    .long 0x3cc90ab0,0x3f7fec43,0xbd7b2b74,0x3f7f84ab,0xbdafb680,0x3f7f0e58,0xbe354098,0x3f7bf531
    .long 0xbf187fc0,0x3f4d9f02,0xbf3085bb,0x3f396842,0xbf2e3bde,0x3f3b8f3b,0xbf44e3f5,0x3f239da9
    .long 0xbf41d870,0x3f273656,0xbf5695e5,0x3f0b9a6b,0xbf531849,0x3f10d3cd,0xbf655e0b,0x3ee363fa
    .long 0xbf7fb10f,0x3d48fb30,0xbf7e1324,0xbdfab273,0xbf7f84ab,0xbd7b2b74,0xbf78b47b,0xbe72b651
    .long 0xbf7c3b28,0xbe2f10a2,0xbf6ff573,0xbeb263ef,0xbf75dec6,0xbe8e9a22,0xbf63f473,0xbee900b7
    .long 0x3f5b941a,0x3f039c3d,0x3f584853,0x3f08f59b,0x3f47de65,0x3f1ff6cb,0x3f42de29,0x3f26050a
    .long 0x3f3085bb,0x3f396842,0x3f299415,0x3f3fc767,0x3f15f6d9,0x3f4f7a1f,0x3f0cead0,0x3f55b993
    .long 0xbd48fb30,0x3f7fb10f,0xbdfab273,0x3f7e1324,0xbe3b6ecf,0x3f7baccd,0xbe8586ce,0x3f772417
    .long 0xbea09ae5,0x3f731447,0xbec9b953,0x3f6b4b0c,0xbee0924f,0x3f660f88,0xbf04f484,0x3f5ac450
    .long 0xbf676bd8,0x3edae880,0xbf731447,0x3ea09ae5,0xbf740bdd,0x3e9aa086,0xbf7bf531,0x3e354098
    .long 0xbf7c3b28,0x3e2f10a2,0xbf7fd397,0x3d16c32c,0xbf7fd397,0x3d16c32c,0xbf7e9bc9,0xbdd53db9
    .long 0xbf4d9f02,0xbf187fc0,0xbf3085bb,0xbf396842,0xbf373a23,0xbf32c8c9,0xbf14b039,0xbf5064af
    .long 0xbf1d7fd1,0xbf49d112,0xbeebcbbb,0xbf633c5a,0xbf00e7e4,0xbf5d2d53,0xbea986c4,0xbf718f57
    .long 0x3f4d9f02,0x3f187fc0,0x3f49d112,0x3f1d7fd1,0x3f32c8c9,0x3f373a23,0x3f2d1469,0x3f3ca003
    .long 0x3f13682a,0x3f514d3d,0x3f0b9a6b,0x3f5695e5,0x3ee0924f,0x3f660f88,0x3ecc9b8b,0x3f6aab7b
    .long 0xbeac7cd4,0x3f710908,0xbecf7bca,0x3f6a09a7,0xbef6e0cb,0x3f604621,0xbf0cead0,0x3f55b993
    .long 0xbf1d7fd1,0x3f49d112,0xbf2e3bde,0x3f3b8f3b,0xbf3b8f3b,0x3f2e3bde,0xbf4ac77f,0x3f1c420c
    .long 0xbf7fb10f,0xbd48fb30,0xbf7c3b28,0xbe2f10a2,0xbf7a7302,0xbe541501,0xbf718f57,0xbea986c4
    .long 0xbf6ed89e,0xbeb8442a,0xbf604621,0xbef6e0cb,0xbf5d2d53,0xbf00e7e4,0xbf48d8b3,0xbf1ebc12
    .long 0xbe78cfcc,0xbf7853f8,0xbd96a905,0xbf7f4e6d,0xbdafb680,0xbf7f0e58,0x3dbc3ac3,0xbf7eea9d
    .long 0x3d96a905,0xbf7f4e6d,0x3e827dc0,0xbf778bc5,0x3e6c9a7f,0xbf791298,0x3ed25a09,0xbf696591
    .long 0x3f3daef9,0x3f2beb4a,0x3f396842,0x3f3085bb,0x3f1b02c6,0x3f4bbbf8,0x3f14b039,0x3f5064af
    .long 0x3ee63375,0x3f64aa59,0x3ed53641,0x3f68bf3c,0x3e8e9a22,0x3f75dec6,0x3e72b651,0x3f78b47b
    .long 0xbf187fc0,0x3f4d9f02,0xbf273656,0x3f41d870,0xbf3b8f3b,0x3f2e3bde,0xbf48d8b3,0x3f1ebc12
    .long 0xbf584853,0x3f08f59b,0xbf633c5a,0x3eebcbbb,0xbf6db293,0x3ebe1d4a,0xbf756d97,0x3e919ddd
    .long 0xbf5b941a,0xbf039c3d,0xbf49d112,0xbf1d7fd1,0xbf3fc767,0xbf299415,0xbf286605,0xbf40d0da
    .long 0xbf1d7fd1,0xbf49d112,0xbf00e7e4,0xbf5d2d53,0xbeebcbbb,0xbf633c5a,0xbea986c4,0xbf718f57
    .long 0x3edae880,0xbf676bd8,0x3f13682a,0xbf514d3d,0x3f15f6d9,0xbf4f7a1f,0x3f385216,0xbf31a81d
    .long 0x3f396842,0xbf3085bb,0x3f5695e5,0xbf0b9a6b,0x3f5695e5,0xbf0b9a6b,0x3f6d1c1d,0xbec1071e
    .long 0x80003680,0x80003680,0x80003680,0x80003680,0x80003680,0xb548367b,0xb5c4366d,0xb60e3655
    .long 0x80003680,0xb5c4366d,0xb6353635,0xb66d35c4,0x80003680,0xb60e3655,0xb66d35c4,0xb67bb548
    .long 0x80003680,0xb6353635,0xb6801b8d,0xb635b635,0x80003680,0xb655360e,0xb66db5c4,0xb548b67b
    .long 0x80003680,0xb66d35c4,0xb635b635,0x35c4b66d,0x80003680,0xb67b3548,0xb5c4b66d,0x3655b60e
    .long 0x80003680,0xb6801b8d,0x9c0db680,0x36809c54,0x80003680,0xb67bb548,0x35c4b66d,0x3655360e
    .long 0x80003680,0xb66db5c4,0x3635b635,0x35c4366d,0x80003680,0xb655b60e,0x366db5c4,0xb548367b
    .long 0x80003680,0xb635b635,0x36809c54,0xb6353635,0x80003680,0xb60eb655,0x366d35c4,0xb67b3548
    .long 0x80003680,0xb5c4b66d,0x36353635,0xb66db5c4,0x80003680,0xb548b67b,0x35c4366d,0xb60eb655
    .long 0x80003680,0x80003680,0x80003680,0x80003680,0xb6353635,0xb655360e,0xb66d35c4,0xb67b3548
    .long 0xb6801b8d,0xb66db5c4,0xb635b635,0xb5c4b66d,0xb635b635,0xb548b67b,0x35c4b66d,0x3655b60e
    .long 0x9c0db680,0x3635b635,0x36809c54,0x36353635,0x3635b635,0x367b3548,0x35c4366d,0xb60e3655
    .long 0x36809c54,0x35c4366d,0xb6353635,0xb66db5c4,0x36353635,0xb60e3655,0xb66db5c4,0x3548b67b
    .long 0x80003680,0xb6801b8d,0x9c0db680,0x36809c54,0xb6353635,0xb60eb655,0x366db5c4,0x3548367b
    .long 0xb6801b8d,0x35c4b66d,0x36353635,0xb66d35c4,0xb635b635,0x367bb548,0xb5c4366d,0xb60eb655
    .long 0x9c0db680,0x36353635,0xb6801b8d,0x3635b635,0x3635b635,0xb548367b,0xb5c4b66d,0x3655360e
    .long 0x36809c54,0xb66d35c4,0x3635b635,0xb5c4366d,0x36353635,0xb655b60e,0x366d35c4,0xb67bb548
    .long 0x80003680,0x80003680,0x80003680,0x80003680,0xb6801b8d,0xb67bb548,0xb66db5c4,0xb655b60e
    .long 0x9c0db680,0x35c4b66d,0x3635b635,0x366db5c4,0x36809c54,0x3655360e,0x35c4366d,0xb548367b
    .long 0x80003680,0xb6353635,0xb6801b8d,0xb635b635,0xb6801b8d,0xb60eb655,0x35c4b66d,0x367bb548
    .long 0x9c0db680,0x366db5c4,0x36353635,0xb5c4366d,0x36809c54,0x3548367b,0xb66d35c4,0xb60eb655
    .long 0x80003680,0xb6801b8d,0x9c0db680,0x36809c54,0xb6801b8d,0x3548b67b,0x366d35c4,0xb60e3655
    .long 0x9c0db680,0x366d35c4,0xb6353635,0xb5c4b66d,0x36809c54,0xb60e3655,0xb5c4b66d,0x367b3548
    .long 0x80003680,0xb635b635,0x36809c54,0xb6353635,0xb6801b8d,0x3655b60e,0xb5c4366d,0xb548b67b
    .long 0x9c0db680,0x35c4366d,0xb635b635,0x366d35c4,0x36809c54,0xb67b3548,0x366db5c4,0xb655360e
    .long 0x80003680,0x80003680,0x80003680,0x80003680,0xb635b635,0xb60eb655,0xb5c4b66d,0xb548b67b
    .long 0x36809c54,0x366d35c4,0x36353635,0x35c4366d,0xb6353635,0xb67b3548,0xb66db5c4,0xb60eb655
    .long 0x9c0db680,0x3635b635,0x36809c54,0x36353635,0x36353635,0xb548367b,0xb66d35c4,0xb655b60e
    .long 0xb6801b8d,0xb5c4b66d,0x3635b635,0x366d35c4,0x3635b635,0x3655360e,0xb5c4366d,0xb67bb548
    .long 0x80003680,0xb6801b8d,0x9c0db680,0x36809c54,0xb635b635,0x3655b60e,0x35c4366d,0xb67b3548
    .long 0x36809c54,0xb5c4366d,0xb635b635,0x366db5c4,0xb6353635,0xb548b67b,0x366d35c4,0xb655360e
    .long 0x9c0db680,0x36353635,0xb6801b8d,0x3635b635,0x36353635,0xb67bb548,0x366db5c4,0xb60e3655
    .long 0xb6801b8d,0x366db5c4,0xb6353635,0x35c4b66d,0x3635b635,0xb60e3655,0x35c4b66d,0xb548367b
    .long 0x80003680,0x9c0db680,0x80003680,0x9c0db680,0x80003680,0x3548b67b,0xb5c4366d,0x360eb655
    .long 0x80003680,0x35c4b66d,0xb6353635,0x366db5c4,0x80003680,0x360eb655,0xb66d35c4,0x367b3548
    .long 0x80003680,0x3635b635,0xb6801b8d,0x36353635,0x80003680,0x3655b60e,0xb66db5c4,0x3548367b
    .long 0x80003680,0x366db5c4,0xb635b635,0xb5c4366d,0x80003680,0x367bb548,0xb5c4b66d,0xb655360e
    .long 0x80003680,0x36809c54,0x9c0db680,0xb6801b8d,0x80003680,0x367b3548,0x35c4b66d,0xb655b60e
    .long 0x80003680,0x366d35c4,0x3635b635,0xb5c4b66d,0x80003680,0x3655360e,0x366db5c4,0x3548b67b
    .long 0x80003680,0x36353635,0x36809c54,0x3635b635,0x80003680,0x360e3655,0x366d35c4,0x367bb548
    .long 0x80003680,0x35c4366d,0x36353635,0x366d35c4,0x80003680,0x3548367b,0x35c4366d,0x360e3655
    .long 0x80003680,0x9c0db680,0x80003680,0x9c0db680,0xb6353635,0x3655b60e,0xb66d35c4,0x367bb548
    .long 0xb6801b8d,0x366d35c4,0xb635b635,0x35c4366d,0xb635b635,0x3548367b,0x35c4b66d,0xb655360e
    .long 0x9c0db680,0xb6353635,0x36809c54,0xb635b635,0x3635b635,0xb67bb548,0x35c4366d,0x360eb655
    .long 0x36809c54,0xb5c4b66d,0xb6353635,0x366d35c4,0x36353635,0x360eb655,0xb66db5c4,0xb548367b
    .long 0x80003680,0x36809c54,0x9c0db680,0xb6801b8d,0xb6353635,0x360e3655,0x366db5c4,0xb548b67b
    .long 0xb6801b8d,0xb5c4366d,0x36353635,0x366db5c4,0xb635b635,0xb67b3548,0xb5c4366d,0x360e3655
    .long 0x9c0db680,0xb635b635,0xb6801b8d,0xb6353635,0x3635b635,0x3548b67b,0xb5c4b66d,0xb655b60e
    .long 0x36809c54,0x366db5c4,0x3635b635,0x35c4b66d,0x36353635,0x3655360e,0x366d35c4,0x367b3548
    .long 0x80003680,0x9c0db680,0x80003680,0x9c0db680,0xb6801b8d,0x367b3548,0xb66db5c4,0x3655360e
    .long 0x9c0db680,0xb5c4366d,0x3635b635,0xb66d35c4,0x36809c54,0xb655b60e,0x35c4366d,0x3548b67b
    .long 0x80003680,0x3635b635,0xb6801b8d,0x36353635,0xb6801b8d,0x360e3655,0x35c4b66d,0xb67b3548
    .long 0x9c0db680,0xb66d35c4,0x36353635,0x35c4b66d,0x36809c54,0xb548b67b,0xb66d35c4,0x360e3655
    .long 0x80003680,0x36809c54,0x9c0db680,0xb6801b8d,0xb6801b8d,0xb548367b,0x366d35c4,0x360eb655
    .long 0x9c0db680,0xb66db5c4,0xb6353635,0x35c4366d,0x36809c54,0x360eb655,0xb5c4b66d,0xb67bb548
    .long 0x80003680,0x36353635,0x36809c54,0x3635b635,0xb6801b8d,0xb655360e,0xb5c4366d,0x3548367b
    .long 0x9c0db680,0xb5c4b66d,0xb635b635,0xb66db5c4,0x36809c54,0x367bb548,0x366db5c4,0x3655b60e
    .long 0x80003680,0x9c0db680,0x80003680,0x9c0db680,0xb635b635,0x360e3655,0xb5c4b66d,0x3548367b
    .long 0x36809c54,0xb66db5c4,0x36353635,0xb5c4b66d,0xb6353635,0x367bb548,0xb66db5c4,0x360e3655
    .long 0x9c0db680,0xb6353635,0x36809c54,0xb635b635,0x36353635,0x3548b67b,0xb66d35c4,0x3655360e
    .long 0xb6801b8d,0x35c4366d,0x3635b635,0xb66db5c4,0x3635b635,0xb655b60e,0xb5c4366d,0x367b3548
    .long 0x80003680,0x36809c54,0x9c0db680,0xb6801b8d,0xb635b635,0xb655360e,0x35c4366d,0x367bb548
    .long 0x36809c54,0x35c4b66d,0xb635b635,0xb66d35c4,0xb6353635,0x3548367b,0x366d35c4,0x3655b60e
    .long 0x9c0db680,0xb635b635,0xb6801b8d,0xb6353635,0x36353635,0x367b3548,0x366db5c4,0x360eb655
    .long 0xb6801b8d,0xb66d35c4,0xb6353635,0xb5c4366d,0x3635b635,0x360eb655,0x35c4b66d,0x3548b67b
    .long 0x80003680,0x80003680,0x80003680,0x80003680,0x9c0db680,0x3548b67b,0x35c4b66d,0x360eb655
    .long 0x80003680,0xb5c4366d,0xb6353635,0xb66d35c4,0x9c0db680,0x360eb655,0x366db5c4,0x367b3548
    .long 0x80003680,0xb6353635,0xb6801b8d,0xb635b635,0x9c0db680,0x3655b60e,0x366d35c4,0x3548367b
    .long 0x80003680,0xb66d35c4,0xb635b635,0x35c4b66d,0x9c0db680,0x367bb548,0x35c4366d,0xb655360e
    .long 0x80003680,0xb6801b8d,0x9c0db680,0x36809c54,0x9c0db680,0x367b3548,0xb5c4366d,0xb655b60e
    .long 0x80003680,0xb66db5c4,0x3635b635,0x35c4366d,0x9c0db680,0x3655360e,0xb66d35c4,0x3548b67b
    .long 0x80003680,0xb635b635,0x36809c54,0xb6353635,0x9c0db680,0x360e3655,0xb66db5c4,0x367bb548
    .long 0x80003680,0xb5c4b66d,0x36353635,0xb66db5c4,0x9c0db680,0x3548367b,0xb5c4b66d,0x360e3655
    .long 0x80003680,0x80003680,0x80003680,0x80003680,0x3635b635,0x3655b60e,0x366db5c4,0x367bb548
    .long 0xb6801b8d,0xb66db5c4,0xb635b635,0xb5c4b66d,0x36353635,0x3548367b,0xb5c4366d,0xb655360e
    .long 0x9c0db680,0x3635b635,0x36809c54,0x36353635,0xb6353635,0xb67bb548,0xb5c4b66d,0x360eb655
    .long 0x36809c54,0x35c4366d,0xb6353635,0xb66db5c4,0xb635b635,0x360eb655,0x366d35c4,0xb548367b
    .long 0x80003680,0xb6801b8d,0x9c0db680,0x36809c54,0x3635b635,0x360e3655,0xb66d35c4,0xb548b67b
    .long 0xb6801b8d,0x35c4b66d,0x36353635,0xb66d35c4,0x36353635,0xb67b3548,0x35c4b66d,0x360e3655
    .long 0x9c0db680,0x36353635,0xb6801b8d,0x3635b635,0xb6353635,0x3548b67b,0x35c4366d,0xb655b60e
    .long 0x36809c54,0xb66d35c4,0x3635b635,0xb5c4366d,0xb635b635,0x3655360e,0xb66db5c4,0x367b3548
    .long 0x80003680,0x80003680,0x80003680,0x80003680,0x36809c54,0x367b3548,0x366d35c4,0x3655360e
    .long 0x9c0db680,0x35c4b66d,0x3635b635,0x366db5c4,0xb6801b8d,0xb655b60e,0xb5c4b66d,0x3548b67b
    .long 0x80003680,0xb6353635,0xb6801b8d,0xb635b635,0x36809c54,0x360e3655,0xb5c4366d,0xb67b3548
    .long 0x9c0db680,0x366db5c4,0x36353635,0xb5c4366d,0xb6801b8d,0xb548b67b,0x366db5c4,0x360e3655
    .long 0x80003680,0xb6801b8d,0x9c0db680,0x36809c54,0x36809c54,0xb548367b,0xb66db5c4,0x360eb655
    .long 0x9c0db680,0x366d35c4,0xb6353635,0xb5c4b66d,0xb6801b8d,0x360eb655,0x35c4366d,0xb67bb548
    .long 0x80003680,0xb635b635,0x36809c54,0xb6353635,0x36809c54,0xb655360e,0x35c4b66d,0x3548367b
    .long 0x9c0db680,0x35c4366d,0xb635b635,0x366d35c4,0xb6801b8d,0x367bb548,0xb66d35c4,0x3655b60e
    .long 0x80003680,0x80003680,0x80003680,0x80003680,0x36353635,0x360e3655,0x35c4366d,0x3548367b
    .long 0x36809c54,0x366d35c4,0x36353635,0x35c4366d,0x3635b635,0x367bb548,0x366d35c4,0x360e3655
    .long 0x9c0db680,0x3635b635,0x36809c54,0x36353635,0xb635b635,0x3548b67b,0x366db5c4,0x3655360e
    .long 0xb6801b8d,0xb5c4b66d,0x3635b635,0x366d35c4,0xb6353635,0xb655b60e,0x35c4b66d,0x367b3548
    .long 0x80003680,0xb6801b8d,0x9c0db680,0x36809c54,0x36353635,0xb655360e,0xb5c4b66d,0x367bb548
    .long 0x36809c54,0xb5c4366d,0xb635b635,0x366db5c4,0x3635b635,0x3548367b,0xb66db5c4,0x3655b60e
    .long 0x9c0db680,0x36353635,0xb6801b8d,0x3635b635,0xb635b635,0x367b3548,0xb66d35c4,0x360eb655
    .long 0xb6801b8d,0x366db5c4,0xb6353635,0x35c4b66d,0xb6353635,0x360eb655,0xb5c4366d,0x3548b67b
    .long 0x80003680,0x9c0db680,0x80003680,0x9c0db680,0x9c0db680,0xb548367b,0x35c4b66d,0xb60e3655
    .long 0x80003680,0x35c4b66d,0xb6353635,0x366db5c4,0x9c0db680,0xb60e3655,0x366db5c4,0xb67bb548
    .long 0x80003680,0x3635b635,0xb6801b8d,0x36353635,0x9c0db680,0xb655360e,0x366d35c4,0xb548b67b
    .long 0x80003680,0x366db5c4,0xb635b635,0xb5c4366d,0x9c0db680,0xb67b3548,0x35c4366d,0x3655b60e
    .long 0x80003680,0x36809c54,0x9c0db680,0xb6801b8d,0x9c0db680,0xb67bb548,0xb5c4366d,0x3655360e
    .long 0x80003680,0x366d35c4,0x3635b635,0xb5c4b66d,0x9c0db680,0xb655b60e,0xb66d35c4,0xb548367b
    .long 0x80003680,0x36353635,0x36809c54,0x3635b635,0x9c0db680,0xb60eb655,0xb66db5c4,0xb67b3548
    .long 0x80003680,0x35c4366d,0x36353635,0x366d35c4,0x9c0db680,0xb548b67b,0xb5c4b66d,0xb60eb655
    .long 0x80003680,0x9c0db680,0x80003680,0x9c0db680,0x3635b635,0xb655360e,0x366db5c4,0xb67b3548
    .long 0xb6801b8d,0x366d35c4,0xb635b635,0x35c4366d,0x36353635,0xb548b67b,0xb5c4366d,0x3655b60e
    .long 0x9c0db680,0xb6353635,0x36809c54,0xb635b635,0xb6353635,0x367b3548,0xb5c4b66d,0xb60e3655
    .long 0x36809c54,0xb5c4b66d,0xb6353635,0x366d35c4,0xb635b635,0xb60e3655,0x366d35c4,0x3548b67b
    .long 0x80003680,0x36809c54,0x9c0db680,0xb6801b8d,0x3635b635,0xb60eb655,0xb66d35c4,0x3548367b
    .long 0xb6801b8d,0xb5c4366d,0x36353635,0x366db5c4,0x36353635,0x367bb548,0x35c4b66d,0xb60eb655
    .long 0x9c0db680,0xb635b635,0xb6801b8d,0xb6353635,0xb6353635,0xb548367b,0x35c4366d,0x3655360e
    .long 0x36809c54,0x366db5c4,0x3635b635,0x35c4b66d,0xb635b635,0xb655b60e,0xb66db5c4,0xb67bb548
    .long 0x80003680,0x9c0db680,0x80003680,0x9c0db680,0x36809c54,0xb67bb548,0x366d35c4,0xb655b60e
    .long 0x9c0db680,0xb5c4366d,0x3635b635,0xb66d35c4,0xb6801b8d,0x3655360e,0xb5c4b66d,0xb548367b
    .long 0x80003680,0x3635b635,0xb6801b8d,0x36353635,0x36809c54,0xb60eb655,0xb5c4366d,0x367bb548
    .long 0x9c0db680,0xb66d35c4,0x36353635,0x35c4b66d,0xb6801b8d,0x3548367b,0x366db5c4,0xb60eb655
    .long 0x80003680,0x36809c54,0x9c0db680,0xb6801b8d,0x36809c54,0x3548b67b,0xb66db5c4,0xb60e3655
    .long 0x9c0db680,0xb66db5c4,0xb6353635,0x35c4366d,0xb6801b8d,0xb60e3655,0x35c4366d,0x367b3548
    .long 0x80003680,0x36353635,0x36809c54,0x3635b635,0x36809c54,0x3655b60e,0x35c4b66d,0xb548b67b
    .long 0x9c0db680,0xb5c4b66d,0xb635b635,0xb66db5c4,0xb6801b8d,0xb67b3548,0xb66d35c4,0xb655360e
    .long 0x80003680,0x9c0db680,0x80003680,0x9c0db680,0x36353635,0xb60eb655,0x35c4366d,0xb548b67b
    .long 0x36809c54,0xb66db5c4,0x36353635,0xb5c4b66d,0x3635b635,0xb67b3548,0x366d35c4,0xb60eb655
    .long 0x9c0db680,0xb6353635,0x36809c54,0xb635b635,0xb635b635,0xb548367b,0x366db5c4,0xb655b60e
    .long 0xb6801b8d,0x35c4366d,0x3635b635,0xb66db5c4,0xb6353635,0x3655360e,0x35c4b66d,0xb67bb548
    .long 0x80003680,0x36809c54,0x9c0db680,0xb6801b8d,0x36353635,0x3655b60e,0xb5c4b66d,0xb67b3548
    .long 0x36809c54,0x35c4b66d,0xb635b635,0xb66d35c4,0x3635b635,0xb548b67b,0xb66db5c4,0xb655360e
    .long 0x9c0db680,0xb635b635,0xb6801b8d,0xb6353635,0xb635b635,0xb67bb548,0xb66d35c4,0xb60e3655
    .long 0xb6801b8d,0xb66d35c4,0xb6353635,0xb5c4366d,0xb6353635,0xb60e3655,0xb5c4366d,0xb548367b
    .long 0x3e803e80,0x3e803e80,0x3e803e80,0x3e803e80,0x3e7b3e80,0x3e553e6d,0x3e0e3e35,0x3d483dc4
    .long 0x3e6d3e80,0x3dc43e35,0xbdc4238d,0xbe6dbe35,0x3e553e80,0xbd483dc4,0xbe7bbe35,0xbe0ebe6d
    .long 0x3e353e80,0xbe35238d,0xbe35be80,0x3e35a454,0x3e0e3e80,0xbe7bbdc4,0x3d48be35,0x3e553e6d
    .long 0x3dc43e80,0xbe6dbe35,0x3e6da454,0xbdc43e35,0x3d483e80,0xbe0ebe6d,0x3e553e35,0xbe7bbdc4
    .long 0x238d3e80,0xa454be80,0x238d3e80,0xa454be80,0xbd483e80,0x3e0ebe6d,0xbe553e35,0x3e7bbdc4
    .long 0xbdc43e80,0x3e6dbe35,0xbe6d238d,0x3dc43e35,0xbe0e3e80,0x3e7bbdc4,0xbd48be35,0xbe553e6d
    .long 0xbe353e80,0x3e35a454,0x3e35be80,0xbe35238d,0xbe553e80,0x3d483dc4,0x3e7bbe35,0x3e0ebe6d
    .long 0xbe6d3e80,0xbdc43e35,0x3dc4a454,0x3e6dbe35,0xbe7b3e80,0xbe553e6d,0xbe0e3e35,0xbd483dc4
    .long 0x3e803e80,0x3e803e80,0x3e803e80,0x3e803e80,0xbd48238d,0xbe0ebdc4,0xbe55be35,0xbe7bbe6d
    .long 0xbe6dbe80,0xbdc4be35,0x3dc4a454,0x3e6d3e35,0x3e0ea454,0x3e7b3e6d,0x3d483e35,0xbe55bdc4
    .long 0x3e353e80,0xbe35238d,0xbe35be80,0x3e35a454,0xbe55238d,0xbd48be6d,0x3e7b3e35,0xbe0e3dc4
    .long 0xbdc4be80,0x3e6d3e35,0xbe6d238d,0x3dc4be35,0x3e7ba454,0xbe553dc4,0x3e0ebe35,0xbd483e6d
    .long 0x238d3e80,0xa454be80,0x238d3e80,0xa454be80,0xbe7b238d,0x3e553dc4,0xbe0ebe35,0x3d483e6d
    .long 0x3dc4be80,0xbe6d3e35,0x3e6da454,0xbdc4be35,0x3e55a454,0x3d48be6d,0xbe7b3e35,0x3e0e3dc4
    .long 0xbe353e80,0x3e35a454,0x3e35be80,0xbe35238d,0xbe0e238d,0xbe7b3e6d,0xbd483e35,0x3e55bdc4
    .long 0x3e6dbe80,0x3dc4be35,0xbdc4238d,0xbe6d3e35,0x3d48a454,0x3e0ebdc4,0x3e55be35,0x3e7bbe6d
    .long 0x3e803e80,0x3e803e80,0x3e803e80,0x3e803e80,0xbe7bbe80,0xbe55be6d,0xbe0ebe35,0xbd48bdc4
    .long 0x3e6d3e80,0x3dc43e35,0xbdc4238d,0xbe6dbe35,0xbe55be80,0x3d48bdc4,0x3e7b3e35,0x3e0e3e6d
    .long 0x3e353e80,0xbe35238d,0xbe35be80,0x3e35a454,0xbe0ebe80,0x3e7b3dc4,0xbd483e35,0xbe55be6d
    .long 0x3dc43e80,0xbe6dbe35,0x3e6da454,0xbdc43e35,0xbd48be80,0x3e0e3e6d,0xbe55be35,0x3e7b3dc4
    .long 0x238d3e80,0xa454be80,0x238d3e80,0xa454be80,0x3d48be80,0xbe0e3e6d,0x3e55be35,0xbe7b3dc4
    .long 0xbdc43e80,0x3e6dbe35,0xbe6d238d,0x3dc43e35,0x3e0ebe80,0xbe7b3dc4,0x3d483e35,0x3e55be6d
    .long 0xbe353e80,0x3e35a454,0x3e35be80,0xbe35238d,0x3e55be80,0xbd48bdc4,0xbe7b3e35,0xbe0e3e6d
    .long 0xbe6d3e80,0xbdc43e35,0x3dc4a454,0x3e6dbe35,0x3e7bbe80,0x3e55be6d,0x3e0ebe35,0x3d48bdc4
    .long 0x3e803e80,0x3e803e80,0x3e803e80,0x3e803e80,0x3d48a454,0x3e0e3dc4,0x3e553e35,0x3e7b3e6d
    .long 0xbe6dbe80,0xbdc4be35,0x3dc4a454,0x3e6d3e35,0xbe0e238d,0xbe7bbe6d,0xbd48be35,0x3e553dc4
    .long 0x3e353e80,0xbe35238d,0xbe35be80,0x3e35a454,0x3e55a454,0x3d483e6d,0xbe7bbe35,0x3e0ebdc4
    .long 0xbdc4be80,0x3e6d3e35,0xbe6d238d,0x3dc4be35,0xbe7b238d,0x3e55bdc4,0xbe0e3e35,0x3d48be6d
    .long 0x238d3e80,0xa454be80,0x238d3e80,0xa454be80,0x3e7ba454,0xbe55bdc4,0x3e0e3e35,0xbd48be6d
    .long 0x3dc4be80,0xbe6d3e35,0x3e6da454,0xbdc4be35,0xbe55238d,0xbd483e6d,0x3e7bbe35,0xbe0ebdc4
    .long 0xbe353e80,0x3e35a454,0x3e35be80,0xbe35238d,0x3e0ea454,0x3e7bbe6d,0x3d48be35,0xbe553dc4
    .long 0x3e6dbe80,0x3dc4be35,0xbdc4238d,0xbe6d3e35,0xbd48238d,0xbe0e3dc4,0xbe553e35,0xbe7b3e6d
    .long 0x80008000,0x80008000,0x80008000,0x80008000,0xbd488000,0xbe0ebdc4,0xbe55be35,0xbe7bbe6d
    .long 0xbdc48000,0xbe6dbe35,0xbe6dbe80,0xbdc4be35,0xbe0e8000,0xbe7bbe6d,0xbd48be35,0x3e553dc4
    .long 0xbe358000,0xbe35be80,0x3e35a40d,0x3e353e80,0xbe558000,0xbd48be6d,0x3e7b3e35,0xbe0e3dc4
    .long 0xbe6d8000,0x3dc4be35,0x3dc43e80,0xbe6dbe35,0xbe7b8000,0x3e55bdc4,0xbe0e3e35,0x3d48be6d
    .long 0xbe808000,0x3e80a40d,0xbe808000,0x3e80a40d,0xbe7b8000,0x3e553dc4,0xbe0ebe35,0x3d483e6d
    .long 0xbe6d8000,0x3dc43e35,0x3dc4be80,0xbe6d3e35,0xbe558000,0xbd483e6d,0x3e7bbe35,0xbe0ebdc4
    .long 0xbe358000,0xbe353e80,0x3e35a40d,0x3e35be80,0xbe0e8000,0xbe7b3e6d,0xbd483e35,0x3e55bdc4
    .long 0xbdc48000,0xbe6d3e35,0xbe6d3e80,0xbdc43e35,0xbd488000,0xbe0e3dc4,0xbe553e35,0xbe7b3e6d
    .long 0x80008000,0x80008000,0x80008000,0x80008000,0xbe7bbe80,0xbe55be6d,0xbe0ebe35,0xbd48bdc4
    .long 0x3dc4a40d,0x3e6d3e35,0x3e6d3e80,0x3dc43e35,0x3e553e80,0xbd483dc4,0xbe7bbe35,0xbe0ebe6d
    .long 0xbe358000,0xbe35be80,0x3e35a40d,0x3e353e80,0xbe0ebe80,0x3e7b3dc4,0xbd483e35,0xbe55be6d
    .long 0x3e6da40d,0xbdc43e35,0xbdc4be80,0x3e6d3e35,0x3d483e80,0xbe0ebe6d,0x3e553e35,0xbe7bbdc4
    .long 0xbe808000,0x3e80a40d,0xbe808000,0x3e80a40d,0x3d48be80,0xbe0e3e6d,0x3e55be35,0xbe7b3dc4
    .long 0x3e6da40d,0xbdc4be35,0xbdc43e80,0x3e6dbe35,0xbe0e3e80,0x3e7bbdc4,0xbd48be35,0xbe553e6d
    .long 0xbe358000,0xbe353e80,0x3e35a40d,0x3e35be80,0x3e55be80,0xbd48bdc4,0xbe7b3e35,0xbe0e3e6d
    .long 0x3dc4a40d,0x3e6dbe35,0x3e6dbe80,0x3dc4be35,0xbe7b3e80,0xbe553e6d,0xbe0e3e35,0xbd483dc4
    .long 0x80008000,0x80008000,0x80008000,0x80008000,0x3d48a40d,0x3e0e3dc4,0x3e553e35,0x3e7b3e6d
    .long 0xbdc48000,0xbe6dbe35,0xbe6dbe80,0xbdc4be35,0x3e0ea40d,0x3e7b3e6d,0x3d483e35,0xbe55bdc4
    .long 0xbe358000,0xbe35be80,0x3e35a40d,0x3e353e80,0x3e55a40d,0x3d483e6d,0xbe7bbe35,0x3e0ebdc4
    .long 0xbe6d8000,0x3dc4be35,0x3dc43e80,0xbe6dbe35,0x3e7ba40d,0xbe553dc4,0x3e0ebe35,0xbd483e6d
    .long 0xbe808000,0x3e80a40d,0xbe808000,0x3e80a40d,0x3e7ba40d,0xbe55bdc4,0x3e0e3e35,0xbd48be6d
    .long 0xbe6d8000,0x3dc43e35,0x3dc4be80,0xbe6d3e35,0x3e55a40d,0x3d48be6d,0xbe7b3e35,0x3e0e3dc4
    .long 0xbe358000,0xbe353e80,0x3e35a40d,0x3e35be80,0x3e0ea40d,0x3e7bbe6d,0x3d48be35,0xbe553dc4
    .long 0xbdc48000,0xbe6d3e35,0xbe6d3e80,0xbdc43e35,0x3d48a40d,0x3e0ebdc4,0x3e55be35,0x3e7bbe6d
    .long 0x80008000,0x80008000,0x80008000,0x80008000,0x3e7b3e80,0x3e553e6d,0x3e0e3e35,0x3d483dc4
    .long 0x3dc4a40d,0x3e6d3e35,0x3e6d3e80,0x3dc43e35,0xbe55be80,0x3d48bdc4,0x3e7b3e35,0x3e0e3e6d
    .long 0xbe358000,0xbe35be80,0x3e35a40d,0x3e353e80,0x3e0e3e80,0xbe7bbdc4,0x3d48be35,0x3e553e6d
    .long 0x3e6da40d,0xbdc43e35,0xbdc4be80,0x3e6d3e35,0xbd48be80,0x3e0e3e6d,0xbe55be35,0x3e7b3dc4
    .long 0xbe808000,0x3e80a40d,0xbe808000,0x3e80a40d,0xbd483e80,0x3e0ebe6d,0xbe553e35,0x3e7bbdc4
    .long 0x3e6da40d,0xbdc4be35,0xbdc43e80,0x3e6dbe35,0x3e0ebe80,0xbe7b3dc4,0x3d483e35,0x3e55be6d
    .long 0xbe358000,0xbe353e80,0x3e35a40d,0x3e35be80,0xbe553e80,0x3d483dc4,0x3e7bbe35,0x3e0ebe6d
    .long 0x3dc4a40d,0x3e6dbe35,0x3e6dbe80,0x3dc4be35,0x3e7bbe80,0x3e55be6d,0x3e0ebe35,0x3d48bdc4
    .long 0xbe803e80,0xbe803e80,0xbe803e80,0xbe803e80,0xbe7b3e80,0xbe553e6d,0xbe0e3e35,0xbd483dc4
    .long 0xbe6d3e80,0xbdc43e35,0x3dc4238d,0x3e6dbe35,0xbe553e80,0x3d483dc4,0x3e7bbe35,0x3e0ebe6d
    .long 0xbe353e80,0x3e35238d,0x3e35be80,0xbe35a454,0xbe0e3e80,0x3e7bbdc4,0xbd48be35,0xbe553e6d
    .long 0xbdc43e80,0x3e6dbe35,0xbe6da454,0x3dc43e35,0xbd483e80,0x3e0ebe6d,0xbe553e35,0x3e7bbdc4
    .long 0xa4543e80,0x238dbe80,0xa4543e80,0x238dbe80,0x3d483e80,0xbe0ebe6d,0x3e553e35,0xbe7bbdc4
    .long 0x3dc43e80,0xbe6dbe35,0x3e6d238d,0xbdc43e35,0x3e0e3e80,0xbe7bbdc4,0x3d48be35,0x3e553e6d
    .long 0x3e353e80,0xbe35a454,0xbe35be80,0x3e35238d,0x3e553e80,0xbd483dc4,0xbe7bbe35,0xbe0ebe6d
    .long 0x3e6d3e80,0x3dc43e35,0xbdc4a454,0xbe6dbe35,0x3e7b3e80,0x3e553e6d,0x3e0e3e35,0x3d483dc4
    .long 0xbe803e80,0xbe803e80,0xbe803e80,0xbe803e80,0x3d48238d,0x3e0ebdc4,0x3e55be35,0x3e7bbe6d
    .long 0x3e6dbe80,0x3dc4be35,0xbdc4a454,0xbe6d3e35,0xbe0ea454,0xbe7b3e6d,0xbd483e35,0x3e55bdc4
    .long 0xbe353e80,0x3e35238d,0x3e35be80,0xbe35a454,0x3e55238d,0x3d48be6d,0xbe7b3e35,0x3e0e3dc4
    .long 0x3dc4be80,0xbe6d3e35,0x3e6d238d,0xbdc4be35,0xbe7ba454,0x3e553dc4,0xbe0ebe35,0x3d483e6d
    .long 0xa4543e80,0x238dbe80,0xa4543e80,0x238dbe80,0x3e7b238d,0xbe553dc4,0x3e0ebe35,0xbd483e6d
    .long 0xbdc4be80,0x3e6d3e35,0xbe6da454,0x3dc4be35,0xbe55a454,0xbd48be6d,0x3e7b3e35,0xbe0e3dc4
    .long 0x3e353e80,0xbe35a454,0xbe35be80,0x3e35238d,0x3e0e238d,0x3e7b3e6d,0x3d483e35,0xbe55bdc4
    .long 0xbe6dbe80,0xbdc4be35,0x3dc4238d,0x3e6d3e35,0xbd48a454,0xbe0ebdc4,0xbe55be35,0xbe7bbe6d
    .long 0xbe803e80,0xbe803e80,0xbe803e80,0xbe803e80,0x3e7bbe80,0x3e55be6d,0x3e0ebe35,0x3d48bdc4
    .long 0xbe6d3e80,0xbdc43e35,0x3dc4238d,0x3e6dbe35,0x3e55be80,0xbd48bdc4,0xbe7b3e35,0xbe0e3e6d
    .long 0xbe353e80,0x3e35238d,0x3e35be80,0xbe35a454,0x3e0ebe80,0xbe7b3dc4,0x3d483e35,0x3e55be6d
    .long 0xbdc43e80,0x3e6dbe35,0xbe6da454,0x3dc43e35,0x3d48be80,0xbe0e3e6d,0x3e55be35,0xbe7b3dc4
    .long 0xa4543e80,0x238dbe80,0xa4543e80,0x238dbe80,0xbd48be80,0x3e0e3e6d,0xbe55be35,0x3e7b3dc4
    .long 0x3dc43e80,0xbe6dbe35,0x3e6d238d,0xbdc43e35,0xbe0ebe80,0x3e7b3dc4,0xbd483e35,0xbe55be6d
    .long 0x3e353e80,0xbe35a454,0xbe35be80,0x3e35238d,0xbe55be80,0x3d48bdc4,0x3e7b3e35,0x3e0e3e6d
    .long 0x3e6d3e80,0x3dc43e35,0xbdc4a454,0xbe6dbe35,0xbe7bbe80,0xbe55be6d,0xbe0ebe35,0xbd48bdc4
    .long 0xbe803e80,0xbe803e80,0xbe803e80,0xbe803e80,0xbd48a454,0xbe0e3dc4,0xbe553e35,0xbe7b3e6d
    .long 0x3e6dbe80,0x3dc4be35,0xbdc4a454,0xbe6d3e35,0x3e0e238d,0x3e7bbe6d,0x3d48be35,0xbe553dc4
    .long 0xbe353e80,0x3e35238d,0x3e35be80,0xbe35a454,0xbe55a454,0xbd483e6d,0x3e7bbe35,0xbe0ebdc4
    .long 0x3dc4be80,0xbe6d3e35,0x3e6d238d,0xbdc4be35,0x3e7b238d,0xbe55bdc4,0x3e0e3e35,0xbd48be6d
    .long 0xa4543e80,0x238dbe80,0xa4543e80,0x238dbe80,0xbe7ba454,0x3e55bdc4,0xbe0e3e35,0x3d48be6d
    .long 0xbdc4be80,0x3e6d3e35,0xbe6da454,0x3dc4be35,0x3e55238d,0x3d483e6d,0xbe7bbe35,0x3e0ebdc4
    .long 0x3e353e80,0xbe35a454,0xbe35be80,0x3e35238d,0xbe0ea454,0xbe7bbe6d,0xbd48be35,0x3e553dc4
    .long 0xbe6dbe80,0xbdc4be35,0x3dc4238d,0x3e6d3e35,0x3d48238d,0x3e0e3dc4,0x3e553e35,0x3e7b3e6d
    .long 0xa40d8000,0xa40d8000,0xa40d8000,0xa40d8000,0x3d488000,0x3e0ebdc4,0x3e55be35,0x3e7bbe6d
    .long 0x3dc48000,0x3e6dbe35,0x3e6dbe80,0x3dc4be35,0x3e0e8000,0x3e7bbe6d,0x3d48be35,0xbe553dc4
    .long 0x3e358000,0x3e35be80,0xbe35a40d,0xbe353e80,0x3e558000,0x3d48be6d,0xbe7b3e35,0x3e0e3dc4
    .long 0x3e6d8000,0xbdc4be35,0xbdc43e80,0x3e6dbe35,0x3e7b8000,0xbe55bdc4,0x3e0e3e35,0xbd48be6d
    .long 0x3e808000,0xbe80a40d,0x3e808000,0xbe80a40d,0x3e7b8000,0xbe553dc4,0x3e0ebe35,0xbd483e6d
    .long 0x3e6d8000,0xbdc43e35,0xbdc4be80,0x3e6d3e35,0x3e558000,0x3d483e6d,0xbe7bbe35,0x3e0ebdc4
    .long 0x3e358000,0x3e353e80,0xbe35a40d,0xbe35be80,0x3e0e8000,0x3e7b3e6d,0x3d483e35,0xbe55bdc4
    .long 0x3dc48000,0x3e6d3e35,0x3e6d3e80,0x3dc43e35,0x3d488000,0x3e0e3dc4,0x3e553e35,0x3e7b3e6d
    .long 0xa40d8000,0xa40d8000,0xa40d8000,0xa40d8000,0x3e7bbe80,0x3e55be6d,0x3e0ebe35,0x3d48bdc4
    .long 0xbdc4a40d,0xbe6d3e35,0xbe6d3e80,0xbdc43e35,0xbe553e80,0x3d483dc4,0x3e7bbe35,0x3e0ebe6d
    .long 0x3e358000,0x3e35be80,0xbe35a40d,0xbe353e80,0x3e0ebe80,0xbe7b3dc4,0x3d483e35,0x3e55be6d
    .long 0xbe6da40d,0x3dc43e35,0x3dc4be80,0xbe6d3e35,0xbd483e80,0x3e0ebe6d,0xbe553e35,0x3e7bbdc4
    .long 0x3e808000,0xbe80a40d,0x3e808000,0xbe80a40d,0xbd48be80,0x3e0e3e6d,0xbe55be35,0x3e7b3dc4
    .long 0xbe6da40d,0x3dc4be35,0x3dc43e80,0xbe6dbe35,0x3e0e3e80,0xbe7bbdc4,0x3d48be35,0x3e553e6d
    .long 0x3e358000,0x3e353e80,0xbe35a40d,0xbe35be80,0xbe55be80,0x3d48bdc4,0x3e7b3e35,0x3e0e3e6d
    .long 0xbdc4a40d,0xbe6dbe35,0xbe6dbe80,0xbdc4be35,0x3e7b3e80,0x3e553e6d,0x3e0e3e35,0x3d483dc4
    .long 0xa40d8000,0xa40d8000,0xa40d8000,0xa40d8000,0xbd48a40d,0xbe0e3dc4,0xbe553e35,0xbe7b3e6d
    .long 0x3dc48000,0x3e6dbe35,0x3e6dbe80,0x3dc4be35,0xbe0ea40d,0xbe7b3e6d,0xbd483e35,0x3e55bdc4
    .long 0x3e358000,0x3e35be80,0xbe35a40d,0xbe353e80,0xbe55a40d,0xbd483e6d,0x3e7bbe35,0xbe0ebdc4
    .long 0x3e6d8000,0xbdc4be35,0xbdc43e80,0x3e6dbe35,0xbe7ba40d,0x3e553dc4,0xbe0ebe35,0x3d483e6d
    .long 0x3e808000,0xbe80a40d,0x3e808000,0xbe80a40d,0xbe7ba40d,0x3e55bdc4,0xbe0e3e35,0x3d48be6d
    .long 0x3e6d8000,0xbdc43e35,0xbdc4be80,0x3e6d3e35,0xbe55a40d,0xbd48be6d,0x3e7b3e35,0xbe0e3dc4
    .long 0x3e358000,0x3e353e80,0xbe35a40d,0xbe35be80,0xbe0ea40d,0xbe7bbe6d,0xbd48be35,0x3e553dc4
    .long 0x3dc48000,0x3e6d3e35,0x3e6d3e80,0x3dc43e35,0xbd48a40d,0xbe0ebdc4,0xbe55be35,0xbe7bbe6d
    .long 0xa40d8000,0xa40d8000,0xa40d8000,0xa40d8000,0xbe7b3e80,0xbe553e6d,0xbe0e3e35,0xbd483dc4
    .long 0xbdc4a40d,0xbe6d3e35,0xbe6d3e80,0xbdc43e35,0x3e55be80,0xbd48bdc4,0xbe7b3e35,0xbe0e3e6d
    .long 0x3e358000,0x3e35be80,0xbe35a40d,0xbe353e80,0xbe0e3e80,0x3e7bbdc4,0xbd48be35,0xbe553e6d
    .long 0xbe6da40d,0x3dc43e35,0x3dc4be80,0xbe6d3e35,0x3d48be80,0xbe0e3e6d,0x3e55be35,0xbe7b3dc4
    .long 0x3e808000,0xbe80a40d,0x3e808000,0xbe80a40d,0x3d483e80,0xbe0ebe6d,0x3e553e35,0xbe7bbdc4
    .long 0xbe6da40d,0x3dc4be35,0x3dc43e80,0xbe6dbe35,0xbe0ebe80,0x3e7b3dc4,0xbd483e35,0xbe55be6d
    .long 0x3e358000,0x3e353e80,0xbe35a40d,0xbe35be80,0x3e553e80,0xbd483dc4,0xbe7bbe35,0xbe0ebe6d
    .long 0xbdc4a40d,0xbe6dbe35,0xbe6dbe80,0xbdc4be35,0xbe7bbe80,0xbe55be6d,0xbe0ebe35,0xbd48bdc4
    .long 0x80003c00,0x80003c00,0x80003c00,0x80003c00,0x80003c00,0xa2483c00,0xa6483bff,0xa8b63bff
    .long 0x80003c00,0xa6483bff,0xaa483bfe,0xacb53bfa,0x80003c00,0xa8b63bff,0xacb53bfa,0xaf0e3bf4
    .long 0x80003c00,0xaa483bfe,0xae463bf6,0xb0b23bea,0x80003c00,0xabd93bfc,0xafd63bf1,0xb1db3bdd
    .long 0x80003c00,0xacb53bfa,0xb0b23bea,0xb3033bce,0x80003c00,0xad7e3bf8,0xb1793be2,0xb4143bbc
    .long 0x80003c00,0xae463bf6,0xb23e3bd9,0xb4a53ba8,0x80003c00,0xaf0e3bf4,0xb3033bce,0xb5343b91
    .long 0x80003c00,0xafd63bf1,0xb3c63bc3,0xb5c23b77,0x80003c00,0xb04e3bed,0xb4443bb6,0xb64e3b5a
    .long 0x80003c00,0xb0b23bea,0xb4a53ba8,0xb6d73b3b,0x80003c00,0xb1153be6,0xb5053b99,0xb75e3b1a
    .long 0x80003c00,0xb1793be2,0xb5643b88,0xb7e33af6,0x80003c00,0xb1db3bdd,0xb5c23b77,0xb8323ad0
    .long 0x80003c00,0x80003c00,0x80003c00,0x80003c00,0xaa483bfe,0xabd93bfc,0xacb53bfa,0xad7e3bf8
    .long 0xae463bf6,0xafd63bf1,0xb0b23bea,0xb1793be2,0xb0b23bea,0xb1db3bdd,0xb3033bce,0xb4143bbc
    .long 0xb23e3bd9,0xb3c63bc3,0xb4a53ba8,0xb5643b88,0xb3c63bc3,0xb4d53ba0,0xb5c23b77,0xb6aa3b46
    .long 0xb4a53ba8,0xb5c23b77,0xb6d73b3b,0xb7e33af6,0xb5643b88,0xb6aa3b46,0xb7e33af6,0xb8873a99
    .long 0xb61f3b64,0xb78b3b0e,0xb8723aa7,0xb9133a2f,0xb6d73b3b,0xb8323ad0,0xb8ec3a4f,0xb99639ba
    .long 0xb78b3b0e,0xb89b3a8a,0xb95f39ed,0xba0f393a,0xb81d3add,0xb9003a3f,0xb9cb3984,0xba7c38b0
    .long 0xb8723aa7,0xb95f39ed,0xba2f3913,0xbadd381d,0xb8c43a6d,0xb9ba3996,0xba8a389b,0xbb303705
    .long 0xb9133a2f,0xba0f393a,0xbadd381d,0xbb7735c2,0xb95f39ed,0xba5e38d8,0xbb253732,0xbbaf3475
    .long 0x80003c00,0x80003c00,0x80003c00,0x80003c00,0xae463bf6,0xaf0e3bf4,0xafd63bf1,0xb04e3bed
    .long 0xb23e3bd9,0xb3033bce,0xb3c63bc3,0xb4443bb6,0xb4a53ba8,0xb5343b91,0xb5c23b77,0xb64e3b5a
    .long 0xb61f3b64,0xb6d73b3b,0xb78b3b0e,0xb81d3add,0xb78b3b0e,0xb8323ad0,0xb89b3a8a,0xb9003a3f
    .long 0xb8723aa7,0xb8ec3a4f,0xb95f39ed,0xb9cb3984,0xb9133a2f,0xb99639ba,0xba0f393a,0xba7c38b0
    .long 0xb9a839a8,0xba2f3913,0xbaa73872,0xbb0e378b,0xba2f3913,0xbab5385d,0xbb253732,0xbb803593
    .long 0xbaa73872,0xbb253732,0xbb883564,0xbbce3303,0xbb0e378b,0xbb803593,0xbbce3303,0xbbf82d7e
    .long 0xbb64361f,0xbbc333c6,0xbbf62e46,0xbbfeaa48,0xbba834a5,0xbbed304e,0xbbffa648,0xbbddb1db
    .long 0xbbd9323e,0xbbff2648,0xbbeab0b2,0xbb99b505,0xbbf62e46,0xbbf8ad7e,0xbbb6b444,0xbb30b705
    .long 0x80003c00,0x80003c00,0x80003c00,0x80003c00,0xb0b23bea,0xb1153be6,0xb1793be2,0xb1db3bdd
    .long 0xb4a53ba8,0xb5053b99,0xb5643b88,0xb5c23b77,0xb6d73b3b,0xb75e3b1a,0xb7e33af6,0xb8323ad0
    .long 0xb8723aa7,0xb8c43a6d,0xb9133a2f,0xb95f39ed,0xb95f39ed,0xb9ba3996,0xba0f393a,0xba5e38d8
    .long 0xba2f3913,0xba8a389b,0xbadd381d,0xbb253732,0xbadd381d,0xbb303705,0xbb7735c2,0xbbaf3475
    .long 0xbb64361f,0xbba834a5,0xbbd9323e,0xbbf62e46,0xbbc333c6,0xbbed304e,0xbbff2648,0xbbf8ad7e
    .long 0xbbf62e46,0xbbffa648,0xbbeab0b2,0xbbb6b444,0xbbfeaa48,0xbbddb1db,0xbb99b505,0xbb30b705
    .long 0xbbd9b23e,0xbb88b564,0xbb0eb78b,0xba6db8c4,0xbb88b564,0xbb02b7b7,0xba4fb8ec,0xb972b9dc
    .long 0xbb0eb78b,0xba4fb8ec,0xb95fb9ed,0xb848bac2,0xba6db8c4,0xb972b9dc,0xb848bac2,0xb5f1bb6e
    .long 0x80003c00,0x80003c00,0x80003c00,0x80003c00,0x9e483c00,0xa4b63c00,0xa7da3bff,0xa97f3bfe
    .long 0xa2483c00,0xa8b63bff,0xabd93bfc,0xad7e3bf8,0xa4b63c00,0xab113bfd,0xade23bf7,0xb01d3bef
    .long 0xa6483bff,0xacb53bfa,0xafd63bf1,0xb1793be2,0xa7da3bff,0xade23bf7,0xb0e43be8,0xb2d23bd1
    .long 0xa8b63bff,0xaf0e3bf4,0xb1db3bdd,0xb4143bbc,0xa97f3bfe,0xb01d3bef,0xb2d23bd1,0xb4bd3ba4
    .long 0xaa483bfe,0xb0b23bea,0xb3c63bc3,0xb5643b88,0xab113bfd,0xb1473be4,0xb45d3bb2,0xb6083b69
    .long 0xabd93bfc,0xb1db3bdd,0xb4d53ba0,0xb6aa3b46,0xac513bfb,0xb26f3bd6,0xb54c3b8c,0xb7483b20
    .long 0xacb53bfa,0xb3033bce,0xb5c23b77,0xb7e33af6,0xad1a3bf9,0xb3963bc6,0xb6373b5f,0xb83d3ac9
    .long 0xad7e3bf8,0xb4143bbc,0xb6aa3b46,0xb8873a99,0xade23bf7,0xb45d3bb2,0xb71b3b2b,0xb8ce3a65
    .long 0x80003c00,0x80003c00,0x80003c00,0x80003c00,0xab113bfd,0xac513bfb,0xad1a3bf9,0xade23bf7
    .long 0xaf0e3bf4,0xb04e3bed,0xb1153be6,0xb1db3bdd,0xb1473be4,0xb26f3bd6,0xb3963bc6,0xb45d3bb2
    .long 0xb3033bce,0xb4443bb6,0xb5053b99,0xb5c23b77,0xb45d3bb2,0xb54c3b8c,0xb6373b5f,0xb71b3b2b
    .long 0xb5343b91,0xb64e3b5a,0xb75e3b1a,0xb8323ad0,0xb6083b69,0xb7483b20,0xb83d3ac9,0xb8ce3a65
    .long 0xb6d73b3b,0xb81d3add,0xb8c43a6d,0xb95f39ed,0xb7a13b08,0xb8913a92,0xb9433a07,0xb9e53969
    .long 0xb8323ad0,0xb9003a3f,0xb9ba3996,0xba5e38d8,0xb8913a92,0xb96939e5,0xba27391d,0xbac9383d
    .long 0xb8ec3a4f,0xb9cb3984,0xba8a389b,0xbb253732,0xb9433a07,0xba27391d,0xbae33812,0xbb7235da
    .long 0xb99639ba,0xba7c38b0,0xbb303705,0xbbaf3475,0xb9e53969,0xbac9383d,0xbb7235da,0xbbdb320d
    .long 0x80003c00,0x80003c00,0x80003c00,0x80003c00,0xaeaa3bf5,0xaf723bf2,0xb01d3bef,0xb0803bec
    .long 0xb2a13bd4,0xb3653bc9,0xb4143bbc,0xb4753baf,0xb4ed3b9d,0xb57c3b84,0xb6083b69,0xb6933b4b
    .long 0xb67c3b50,0xb7323b25,0xb7e33af6,0xb8483ac2,0xb7f93af0,0xb8673aae,0xb8ce3a65,0xb9303a17
    .long 0xb8b03a7c,0xb9273a1f,0xb99639ba,0xb9fe394d,0xb95639f6,0xb9d4397b,0xba4738f6,0xbaae3867
    .long 0xb9ed395f,0xba6d38c4,0xbadd381d,0xbb3b36d7,0xba7438ba,0xbaf037f9,0xbb553665,0xbba434bd
    .long 0xbae93807,0xbb5a364e,0xbbaf3475,0xbbe63115,0xbb4b3693,0xbbab348d,0xbbe830e4,0xbc0024b6
    .long 0xbb993505,0xbbe23179,0xbbff2648,0xbbf1afd6,0xbbd132d2,0xbbfd2b11,0xbbf5aeaa,0xbbb9b42c
    .long 0xbbf42f0e,0xbbfcabd9,0xbbc9b365,0xbb5ab64e,0xbc001e48,0xbbe0b1aa,0xbb7bb5ab,0xbad6b828
    .long 0x80003c00,0x80003c00,0x80003c00,0x80003c00,0xb0e43be8,0xb1473be4,0xb1aa3be0,0xb20d3bdb
    .long 0xb4d53ba0,0xb5343b91,0xb5933b80,0xb5f13b6e,0xb71b3b2b,0xb7a13b08,0xb8123ae3,0xb8523abc
    .long 0xb89b3a8a,0xb8ec3a4f,0xb93a3a0f,0xb98439cb,0xb98d39c3,0xb9e53969,0xba373909,0xba8338a6
    .long 0xba5e38d8,0xbab5385d,0xbb0237b7,0xbb4636aa,0xbb0837a1,0xbb553665,0xbb95351d,0xbbc63396
    .long 0xbb883564,0xbbc333c6,0xbbea30b2,0xbbfe2a48,0xbbdb320d,0xbbf92d1a,0xbbffa7da,0xbbecb080
    .long 0xbbff28b6,0xbbf8ad7e,0xbbd4b2a1,0xbb91b534,0xbbf2af72,0xbbc0b3f7,0xbb69b608,0xbaf0b7f9
    .long 0xbbb6b444,0xbb50b67c,0xbac2b848,0xba0fb93a,0xbb4bb693,0xbaaeb867,0xb9e5b969,0xb8f6ba47
    .long 0xbab5b85d,0xb9dcb972,0xb8d8ba5e,0xb75ebb1a,0xb9f6b956,0xb8e2ba56,0xb748bb20,0xb48dbbab
    .long 0x80003c00,0xb23e3bd9,0xb61f3b64,0xb8723aa7,0x80003c00,0xb2a13bd4,0xb67c3b50,0xb8b03a7c
    .long 0x80003c00,0xb3033bce,0xb6d73b3b,0xb8ec3a4f,0x80003c00,0xb3653bc9,0xb7323b25,0xb9273a1f
    .long 0x80003c00,0xb3c63bc3,0xb78b3b0e,0xb95f39ed,0x80003c00,0xb4143bbc,0xb7e33af6,0xb99639ba
    .long 0x80003c00,0xb4443bb6,0xb81d3add,0xb9cb3984,0x80003c00,0xb4753baf,0xb8483ac2,0xb9fe394d
    .long 0x80003c00,0xb4a53ba8,0xb8723aa7,0xba2f3913,0x80003c00,0xb4d53ba0,0xb89b3a8a,0xba5e38d8
    .long 0x80003c00,0xb5053b99,0xb8c43a6d,0xba8a389b,0x80003c00,0xb5343b91,0xb8ec3a4f,0xbab5385d
    .long 0x80003c00,0xb5643b88,0xb9133a2f,0xbadd381d,0x80003c00,0xb5933b80,0xb93a3a0f,0xbb0237b7
    .long 0x80003c00,0xb5c23b77,0xb95f39ed,0xbb253732,0x80003c00,0xb5f13b6e,0xb98439cb,0xbb4636aa
    .long 0xb9a839a8,0xbaa73872,0xbb64361f,0xbbd9323e,0xb9ed395f,0xbae93807,0xbb993505,0xbbf42f0e
    .long 0xba2f3913,0xbb253732,0xbbc333c6,0xbbff2648,0xba6d38c4,0xbb5a364e,0xbbe23179,0xbbfcabd9
    .long 0xbaa73872,0xbb883564,0xbbf62e46,0xbbeab0b2,0xbadd381d,0xbbaf3475,0xbbff2648,0xbbc9b365
    .long 0xbb0e378b,0xbbce3303,0xbbfeaa48,0xbb99b505,0xbb3b36d7,0xbbe63115,0xbbf1afd6,0xbb5ab64e
    .long 0xbb64361f,0xbbf62e46,0xbbd9b23e,0xbb0eb78b,0xbb883564,0xbbff28b6,0xbbb6b444,0xbab5b85d
    .long 0xbba834a5,0xbbffa648,0xbb88b564,0xba4fb8ec,0xbbc333c6,0xbbf8ad7e,0xbb50b67c,0xb9dcb972
    .long 0xbbd9323e,0xbbeab0b2,0xbb0eb78b,0xb95fb9ed,0xbbea30b2,0xbbd4b2a1,0xbac2b848,0xb8d8ba5e
    .long 0xbbf62e46,0xbbb6b444,0xba6db8c4,0xb848bac2,0xbbfe2a48,0xbb91b534,0xba0fb93a,0xb75ebb1a
    .long 0xbc000000,0xbbd9b23e,0xbb64b61f,0xbaa7b872,0xbbf6ae46,0xbba0b4d5,0xbaf6b7e3,0xb9feb94d
    .long 0xbbd9b23e,0xbb50b67c,0xba6db8c4,0xb93aba0f,0xbba8b4a5,0xbae9b807,0xb9cbb984,0xb85dbab5
    .long 0xbb64b61f,0xba6db8c4,0xb913ba2f,0xb6d7bb3b,0xbb0eb78b,0xb9dcb972,0xb848bac2,0xb4d5bba0
    .long 0xbaa7b872,0xb93aba0f,0xb6d7bb3b,0xb179bbe2,0xba2fb913,0xb887ba99,0xb505bb99,0xa8b6bbff
    .long 0xb9a8b9a8,0xb78bbb0e,0xb23ebbd9,0x2e46bbf6,0xb913ba2f,0xb5f1bb6e,0xacb5bbfa,0x3365bbc9
    .long 0xb872baa7,0xb444bbb6,0x2a48bbfe,0x35c2bb77,0xb78bbb0e,0xb115bbe6,0x3179bbe2,0x37b7bb02
    .long 0xb61fbb64,0xaa48bbfe,0x34a5bba8,0x38c4ba6d,0xb4a5bba8,0x2bd9bbfc,0x367cbb50,0x3996b9ba
    .long 0xb23ebbd9,0x3179bbe2,0x381dbadd,0x3a4fb8ec,0xae46bbf6,0x3475bbaf,0x38ecba4f,0x3ae9b807
    .long 0xb9a8b9a8,0xb872baa7,0xb61fbb64,0xb23ebbd9,0xb8c4ba6d,0xb6aabb46,0xb303bbce,0xa248bc00
    .long 0xb78bbb0e,0xb444bbb6,0xaa48bbfe,0x3179bbe2,0xb564bb88,0xaf0ebbf4,0x2fd6bbf1,0x3593bb80
    .long 0xb23ebbd9,0x2a48bbfe,0x34a5bba8,0x381dbadd,0xaa48bbfe,0x32a1bbd4,0x3732bb25,0x394db9fe
    .long 0x2e46bbf6,0x35c2bb77,0x38c4ba6d,0x3a4fb8ec,0x33c6bbc3,0x3807bae9,0x39cbb984,0x3b1ab75e
    .long 0x361fbb64,0x3913ba2f,0x3aa7b872,0x3ba8b4a5,0x381dbadd,0x39feb94d,0x3b50b67c,0x3bf4af0e
    .long 0x3913ba2f,0x3ac2b848,0x3bc3b3c6,0x3bfa2cb5,0x39edb95f,0x3b5ab64e,0x3bfaacb5,0x3bbc3414
    .long 0x3aa7b872,0x3bc3b3c6,0x3bf62e46,0x3b3b36d7,0x3b3bb6d7,0x3bf8ad7e,0x3bb63444,0x3a7c38b0
    .long 0x3ba8b4a5,0x3bfa2cb5,0x3b3b36d7,0x398439cb,0x3beab0b2,0x3bc93365,0x3a8a389b,0x385d3ab5
    .long 0xae463bf6,0xb4a53ba8,0xb78b3b0e,0xb9133a2f,0xaeaa3bf5,0xb4ed3b9d,0xb7f93af0,0xb95639f6
    .long 0xaf0e3bf4,0xb5343b91,0xb8323ad0,0xb99639ba,0xaf723bf2,0xb57c3b84,0xb8673aae,0xb9d4397b
    .long 0xafd63bf1,0xb5c23b77,0xb89b3a8a,0xba0f393a,0xb01d3bef,0xb6083b69,0xb8ce3a65,0xba4738f6
    .long 0xb04e3bed,0xb64e3b5a,0xb9003a3f,0xba7c38b0,0xb0803bec,0xb6933b4b,0xb9303a17,0xbaae3867
    .long 0xb0b23bea,0xb6d73b3b,0xb95f39ed,0xbadd381d,0xb0e43be8,0xb71b3b2b,0xb98d39c3,0xbb0837a1
    .long 0xb1153be6,0xb75e3b1a,0xb9ba3996,0xbb303705,0xb1473be4,0xb7a13b08,0xb9e53969,0xbb553665
    .long 0xb1793be2,0xb7e33af6,0xba0f393a,0xbb7735c2,0xb1aa3be0,0xb8123ae3,0xba373909,0xbb95351d
    .long 0xb1db3bdd,0xb8323ad0,0xba5e38d8,0xbbaf3475,0xb20d3bdb,0xb8523abc,0xba8338a6,0xbbc63396
    .long 0xba2f3913,0xbb0e378b,0xbba834a5,0xbbf62e46,0xba7438ba,0xbb4b3693,0xbbd132d2,0xbc001e48
    .long 0xbab5385d,0xbb803593,0xbbed304e,0xbbf8ad7e,0xbaf037f9,0xbbab348d,0xbbfd2b11,0xbbe0b1aa
    .long 0xbb253732,0xbbce3303,0xbbffa648,0xbbb6b444,0xbb553665,0xbbe830e4,0xbbf5aeaa,0xbb7bb5ab
    .long 0xbb803593,0xbbf82d7e,0xbbddb1db,0xbb30b705,0xbba434bd,0xbc0024b6,0xbbb9b42c,0xbad6b828
    .long 0xbbc333c6,0xbbfeaa48,0xbb88b564,0xba6db8c4,0xbbdb320d,0xbbf2af72,0xbb4bb693,0xb9f6b956
    .long 0xbbed304e,0xbbddb1db,0xbb02b7b7,0xb972b9dc,0xbbf92d1a,0xbbc0b3f7,0xbaaeb867,0xb8e2ba56
    .long 0xbbff2648,0xbb99b505,0xba4fb8ec,0xb848bac2,0xbbffa7da,0xbb69b608,0xb9e5b969,0xb748bb20
    .long 0xbbf8ad7e,0xbb30b705,0xb972b9dc,0xb5f1bb6e,0xbbecb080,0xbaf0b7f9,0xb8f6ba47,0xb48dbbab
    .long 0xbbf6ae46,0xbba8b4a5,0xbb0eb78b,0xba2fb913,0xbbd6b26f,0xbb55b665,0xba83b8a6,0xb969b9e5
    .long 0xbba0b4d5,0xbae9b807,0xb9dcb972,0xb887ba99,0xbb55b665,0xba65b8ce,0xb91dba27,0xb71bbb2b
    .long 0xbaf6b7e3,0xb9cbb984,0xb848bac2,0xb505bb99,0xba83b8a6,0xb91dba27,0xb6c1bb41,0xb1aabbe0
    .long 0xb9feb94d,0xb85dbab5,0xb4d5bba0,0xa8b6bbff,0xb969b9e5,0xb71bbb2b,0xb1aabbe0,0x2eaabbf5
    .long 0xb8c4ba6d,0xb564bb88,0xaa48bbfe,0x33c6bbc3,0xb812bae3,0xb334bbcb,0x2d1abbf9,0x3608bb69
    .long 0xb6aabb46,0xaf0ebbf4,0x32a1bbd4,0x3807bae9,0xb51dbb95,0x1e48bc00,0x354cbb8c,0x38f6ba47
    .long 0xb303bbce,0x2fd6bbf1,0x3732bb25,0x39cbb984,0xaf72bbf2,0x3396bbc6,0x387cbaa0,0x3a83b8a6
    .long 0xa248bc00,0x3593bb80,0x394db9fe,0x3b1ab75e,0x2de2bbf7,0x3748bb20,0x3a07b943,0x3b8cb54c
    .long 0xb913ba2f,0xb78bbb0e,0xb4a5bba8,0xae46bbf6,0xb812bae3,0xb51dbb95,0xaf72bbf2,0x2de2bbf7
    .long 0xb5f1bb6e,0xb115bbe6,0x2bd9bbfc,0x3475bbaf,0xb334bbcb,0x1e48bc00,0x3396bbc6,0x3748bb20
    .long 0xacb5bbfa,0x3179bbe2,0x367cbb50,0x38ecba4f,0x2d1abbf9,0x354cbb8c,0x387cbaa0,0x3a07b943
    .long 0x3365bbc9,0x37b7bb02,0x3996b9ba,0x3ae9b807,0x3608bb69,0x38f6ba47,0x3a83b8a6,0x3b8cb54c
    .long 0x381dbadd,0x39edb95f,0x3b3bb6d7,0x3beab0b2,0x391dba27,0x3abcb852,0x3bb9b42c,0x3bfe297f
    .long 0x39feb94d,0x3b5ab64e,0x3bf8ad7e,0x3bc93365,0x3abcb852,0x3bc6b396,0x3bf72de2,0x3b4b3693
    .long 0x3b50b67c,0x3bfaacb5,0x3bb63444,0x3a8a389b,0x3bb9b42c,0x3bf72de2,0x3b3636ee,0x398d39c3
    .long 0x3bf4af0e,0x3bbc3414,0x3a7c38b0,0x385d3ab5,0x3bfe297f,0x3b4b3693,0x398d39c3,0x36083b69
    .long 0x3c00,0x3c00,0x3c00,0x3c00,0x3c008000,0x3c008000,0x3c008000,0x3c008000
    .long 0x3c00,0x361f3b64,0x39a839a8,0x3b64361f,0x3c008000,0x3b64b61f,0x39a8b9a8,0x361fbb64
    .long 0x3c00,0x39a839a8,0x3c000000,0x39a8b9a8,0x3c008000,0x39a8b9a8,0xbc00,0xb9a8b9a8
    .long 0x3c00,0x3b64361f,0x39a8b9a8,0xb61fbb64,0x3c008000,0x361fbb64,0xb9a8b9a8,0xbb64361f
    .long 0x3c00,0x3c000000,0xbc00,0xbc008000,0x3c008000,0xbc00,0xbc008000,0x80003c00
    .long 0x3c00,0x3b64b61f,0xb9a8b9a8,0xb61f3b64,0x3c008000,0xb61fbb64,0xb9a839a8,0x3b64361f
    .long 0x3c00,0x39a8b9a8,0xbc008000,0x39a839a8,0x3c008000,0xb9a8b9a8,0x80003c00,0x39a8b9a8
    .long 0x3c00,0x361fbb64,0xb9a839a8,0x3b64b61f,0x3c008000,0xbb64b61f,0x39a839a8,0xb61fbb64
    .long 0x3c00,0x3c00,0x3c00,0x3c00,0x3c008000,0x3c008000,0x3c008000,0x3c008000
    .long 0x3c000000,0x3b64b61f,0x39a8b9a8,0x361fbb64,0xbc00,0xb61fbb64,0xb9a8b9a8,0xbb64b61f
    .long 0xbc00,0xb9a8b9a8,0xbc008000,0xb9a839a8,0xbc008000,0xb9a839a8,0x80003c00,0x39a839a8
    .long 0xbc008000,0xb61f3b64,0x39a839a8,0x3b64b61f,0x80003c00,0x3b64361f,0x39a8b9a8,0xb61fbb64
    .long 0x3c00,0x3c000000,0xbc00,0xbc008000,0x3c008000,0xbc00,0xbc008000,0x80003c00
    .long 0x3c000000,0xb61fbb64,0xb9a839a8,0x3b64361f,0xbc00,0xbb64361f,0x39a839a8,0x361fbb64
    .long 0xbc00,0xb9a839a8,0x3c000000,0xb9a8b9a8,0xbc008000,0x39a839a8,0xbc00,0xb9a839a8
    .long 0xbc008000,0x3b64361f,0xb9a8b9a8,0x361f3b64,0x80003c00,0x361fbb64,0xb9a839a8,0x3b64b61f
    .long 0x3c00,0x3c00,0x3c00,0x3c00,0x3c008000,0x3c008000,0x3c008000,0x3c008000
    .long 0xbc00,0xb61fbb64,0xb9a8b9a8,0xbb64b61f,0xbc008000,0xbb64361f,0xb9a839a8,0xb61f3b64
    .long 0x3c00,0x39a839a8,0x3c000000,0x39a8b9a8,0x3c008000,0x39a8b9a8,0xbc00,0xb9a8b9a8
    .long 0xbc00,0xbb64b61f,0xb9a839a8,0x361f3b64,0xbc008000,0xb61f3b64,0x39a839a8,0x3b64b61f
    .long 0x3c00,0x3c000000,0xbc00,0xbc008000,0x3c008000,0xbc00,0xbc008000,0x80003c00
    .long 0xbc00,0xbb64361f,0x39a839a8,0x361fbb64,0xbc008000,0x361f3b64,0x39a8b9a8,0xbb64b61f
    .long 0x3c00,0x39a8b9a8,0xbc008000,0x39a839a8,0x3c008000,0xb9a8b9a8,0x80003c00,0x39a8b9a8
    .long 0xbc00,0xb61f3b64,0x39a8b9a8,0xbb64361f,0xbc008000,0x3b64361f,0xb9a8b9a8,0x361f3b64
    .long 0x3c00,0x3c00,0x3c00,0x3c00,0x3c008000,0x3c008000,0x3c008000,0x3c008000
    .long 0xbc008000,0xbb64361f,0xb9a839a8,0xb61f3b64,0x80003c00,0x361f3b64,0x39a839a8,0x3b64361f
    .long 0xbc00,0xb9a8b9a8,0xbc008000,0xb9a839a8,0xbc008000,0xb9a839a8,0x80003c00,0x39a839a8
    .long 0x3c000000,0x361fbb64,0xb9a8b9a8,0xbb64361f,0xbc00,0xbb64b61f,0xb9a839a8,0x361f3b64
    .long 0x3c00,0x3c000000,0xbc00,0xbc008000,0x3c008000,0xbc00,0xbc008000,0x80003c00
    .long 0xbc008000,0x361f3b64,0x39a8b9a8,0xbb64b61f,0x80003c00,0x3b64b61f,0xb9a8b9a8,0xb61f3b64
    .long 0xbc00,0xb9a839a8,0x3c000000,0xb9a8b9a8,0xbc008000,0x39a839a8,0xbc00,0xb9a839a8
    .long 0x3c000000,0xbb64b61f,0x39a839a8,0xb61fbb64,0xbc00,0xb61f3b64,0x39a8b9a8,0xbb64361f
    .long 0x3c00,0xbc00,0x3c00,0xbc00,0x3c008000,0xbc008000,0x3c008000,0xbc008000
    .long 0x3c00,0xb61fbb64,0x39a839a8,0xbb64b61f,0x3c008000,0xbb64361f,0x39a8b9a8,0xb61f3b64
    .long 0x3c00,0xb9a8b9a8,0x3c000000,0xb9a839a8,0x3c008000,0xb9a839a8,0xbc00,0x39a839a8
    .long 0x3c00,0xbb64b61f,0x39a8b9a8,0x361f3b64,0x3c008000,0xb61f3b64,0xb9a8b9a8,0x3b64b61f
    .long 0x3c00,0xbc008000,0xbc00,0x3c000000,0x3c008000,0x80003c00,0xbc008000,0xbc00
    .long 0x3c00,0xbb64361f,0xb9a8b9a8,0x361fbb64,0x3c008000,0x361f3b64,0xb9a839a8,0xbb64b61f
    .long 0x3c00,0xb9a839a8,0xbc008000,0xb9a8b9a8,0x3c008000,0x39a839a8,0x80003c00,0xb9a839a8
    .long 0x3c00,0xb61f3b64,0xb9a839a8,0xbb64361f,0x3c008000,0x3b64361f,0x39a839a8,0x361f3b64
    .long 0x3c00,0xbc00,0x3c00,0xbc00,0x3c008000,0xbc008000,0x3c008000,0xbc008000
    .long 0x3c000000,0xbb64361f,0x39a8b9a8,0xb61f3b64,0xbc00,0x361f3b64,0xb9a8b9a8,0x3b64361f
    .long 0xbc00,0x39a839a8,0xbc008000,0x39a8b9a8,0xbc008000,0x39a8b9a8,0x80003c00,0xb9a8b9a8
    .long 0xbc008000,0x361fbb64,0x39a839a8,0xbb64361f,0x80003c00,0xbb64b61f,0x39a8b9a8,0x361f3b64
    .long 0x3c00,0xbc008000,0xbc00,0x3c000000,0x3c008000,0x80003c00,0xbc008000,0xbc00
    .long 0x3c000000,0x361f3b64,0xb9a839a8,0xbb64b61f,0xbc00,0x3b64b61f,0x39a839a8,0xb61f3b64
    .long 0xbc00,0x39a8b9a8,0x3c000000,0x39a839a8,0xbc008000,0xb9a8b9a8,0xbc00,0x39a8b9a8
    .long 0xbc008000,0xbb64b61f,0xb9a8b9a8,0xb61fbb64,0x80003c00,0xb61f3b64,0xb9a839a8,0xbb64361f
    .long 0x3c00,0xbc00,0x3c00,0xbc00,0x3c008000,0xbc008000,0x3c008000,0xbc008000
    .long 0xbc00,0x361f3b64,0xb9a8b9a8,0x3b64361f,0xbc008000,0x3b64b61f,0xb9a839a8,0x361fbb64
    .long 0x3c00,0xb9a8b9a8,0x3c000000,0xb9a839a8,0x3c008000,0xb9a839a8,0xbc00,0x39a839a8
    .long 0xbc00,0x3b64361f,0xb9a839a8,0xb61fbb64,0xbc008000,0x361fbb64,0x39a839a8,0xbb64361f
    .long 0x3c00,0xbc008000,0xbc00,0x3c000000,0x3c008000,0x80003c00,0xbc008000,0xbc00
    .long 0xbc00,0x3b64b61f,0x39a839a8,0xb61f3b64,0xbc008000,0xb61fbb64,0x39a8b9a8,0x3b64361f
    .long 0x3c00,0xb9a839a8,0xbc008000,0xb9a8b9a8,0x3c008000,0x39a839a8,0x80003c00,0xb9a839a8
    .long 0xbc00,0x361fbb64,0x39a8b9a8,0x3b64b61f,0xbc008000,0xbb64b61f,0xb9a8b9a8,0xb61fbb64
    .long 0x3c00,0xbc00,0x3c00,0xbc00,0x3c008000,0xbc008000,0x3c008000,0xbc008000
    .long 0xbc008000,0x3b64b61f,0xb9a839a8,0x361fbb64,0x80003c00,0xb61fbb64,0x39a839a8,0xbb64b61f
    .long 0xbc00,0x39a839a8,0xbc008000,0x39a8b9a8,0xbc008000,0x39a8b9a8,0x80003c00,0xb9a8b9a8
    .long 0x3c000000,0xb61f3b64,0xb9a8b9a8,0x3b64b61f,0xbc00,0x3b64361f,0xb9a839a8,0xb61fbb64
    .long 0x3c00,0xbc008000,0xbc00,0x3c000000,0x3c008000,0x80003c00,0xbc008000,0xbc00
    .long 0xbc008000,0xb61fbb64,0x39a8b9a8,0x3b64361f,0x80003c00,0xbb64361f,0xb9a8b9a8,0x361fbb64
    .long 0xbc00,0x39a8b9a8,0x3c000000,0x39a839a8,0xbc008000,0xb9a8b9a8,0xbc00,0x39a8b9a8
    .long 0x3c000000,0x3b64361f,0x39a839a8,0x361f3b64,0xbc00,0x361fbb64,0x39a8b9a8,0x3b64b61f
    .long 0x3c00,0x3c00,0x3c00,0x3c00,0x3c008000,0x3c008000,0x3c008000,0x3c008000
    .long 0x323e3bd9,0x38723aa7,0x3aa73872,0x3bd9323e,0x3bd9b23e,0x3aa7b872,0x3872baa7,0x323ebbd9
    .long 0x361f3b64,0x3b64361f,0x3b64b61f,0x361fbb64,0x3b64b61f,0x361fbb64,0xb61fbb64,0xbb64b61f
    .long 0x38723aa7,0x3bd9b23e,0x323ebbd9,0xbaa7b872,0x3aa7b872,0xb23ebbd9,0xbbd9b23e,0xb8723aa7
    .long 0x39a839a8,0x39a8b9a8,0xb9a8b9a8,0xb9a839a8,0x39a8b9a8,0xb9a8b9a8,0xb9a839a8,0x39a839a8
    .long 0x3aa73872,0x323ebbd9,0xbbd9323e,0x38723aa7,0x3872baa7,0xbbd9b23e,0x323e3bd9,0x3aa7b872
    .long 0x3b64361f,0xb61fbb64,0xb61f3b64,0x3b64b61f,0x361fbb64,0xbb64361f,0x3b64361f,0xb61fbb64
    .long 0x3bd9323e,0xbaa7b872,0x38723aa7,0xb23ebbd9,0x323ebbd9,0xb8723aa7,0x3aa7b872,0xbbd9323e
    .long 0x3c00,0x3c00,0x3c00,0x3c00,0x3c008000,0x3c008000,0x3c008000,0x3c008000
    .long 0x3bd9b23e,0x3aa7b872,0x3872baa7,0x323ebbd9,0xb23ebbd9,0xb872baa7,0xbaa7b872,0xbbd9b23e
    .long 0xb61fbb64,0xbb64b61f,0xbb64361f,0xb61f3b64,0xbb64361f,0xb61f3b64,0x361f3b64,0x3b64361f
    .long 0xbaa73872,0x323e3bd9,0x3bd9323e,0x3872baa7,0x38723aa7,0x3bd9b23e,0x323ebbd9,0xbaa7b872
    .long 0x39a839a8,0x39a8b9a8,0xb9a8b9a8,0xb9a839a8,0x39a8b9a8,0xb9a8b9a8,0xb9a839a8,0x39a839a8
    .long 0x3872baa7,0xbbd9b23e,0x323e3bd9,0x3aa7b872,0xbaa7b872,0xb23e3bd9,0x3bd9b23e,0xb872baa7
    .long 0xbb64b61f,0x361f3b64,0x361fbb64,0xbb64361f,0xb61f3b64,0x3b64b61f,0xbb64b61f,0x361f3b64
    .long 0xb23e3bd9,0x3872baa7,0xbaa73872,0x3bd9b23e,0x3bd9323e,0xbaa7b872,0x38723aa7,0xb23ebbd9
    .long 0x3c00,0x3c00,0x3c00,0x3c00,0x3c008000,0x3c008000,0x3c008000,0x3c008000
    .long 0xb23ebbd9,0xb872baa7,0xbaa7b872,0xbbd9b23e,0xbbd9323e,0xbaa73872,0xb8723aa7,0xb23e3bd9
    .long 0x361f3b64,0x3b64361f,0x3b64b61f,0x361fbb64,0x3b64b61f,0x361fbb64,0xb61fbb64,0xbb64b61f
    .long 0xb872baa7,0xbbd9323e,0xb23e3bd9,0x3aa73872,0xbaa73872,0x323e3bd9,0x3bd9323e,0x3872baa7
    .long 0x39a839a8,0x39a8b9a8,0xb9a8b9a8,0xb9a839a8,0x39a8b9a8,0xb9a8b9a8,0xb9a839a8,0x39a839a8
    .long 0xbaa7b872,0xb23e3bd9,0x3bd9b23e,0xb872baa7,0xb8723aa7,0x3bd9323e,0xb23ebbd9,0xbaa73872
    .long 0x3b64361f,0xb61fbb64,0xb61f3b64,0x3b64b61f,0x361fbb64,0xbb64361f,0x3b64361f,0xb61fbb64
    .long 0xbbd9b23e,0x3aa73872,0xb872baa7,0x323e3bd9,0xb23e3bd9,0x3872baa7,0xbaa73872,0x3bd9b23e
    .long 0x3c00,0x3c00,0x3c00,0x3c00,0x3c008000,0x3c008000,0x3c008000,0x3c008000
    .long 0xbbd9323e,0xbaa73872,0xb8723aa7,0xb23e3bd9,0x323e3bd9,0x38723aa7,0x3aa73872,0x3bd9323e
    .long 0xb61fbb64,0xbb64b61f,0xbb64361f,0xb61f3b64,0xbb64361f,0xb61f3b64,0x361f3b64,0x3b64361f
    .long 0x3aa7b872,0xb23ebbd9,0xbbd9b23e,0xb8723aa7,0xb872baa7,0xbbd9323e,0xb23e3bd9,0x3aa73872
    .long 0x39a839a8,0x39a8b9a8,0xb9a8b9a8,0xb9a839a8,0x39a8b9a8,0xb9a8b9a8,0xb9a839a8,0x39a839a8
    .long 0xb8723aa7,0x3bd9323e,0xb23ebbd9,0xbaa73872,0x3aa73872,0x323ebbd9,0xbbd9323e,0x38723aa7
    .long 0xbb64b61f,0x361f3b64,0x361fbb64,0xbb64361f,0xb61f3b64,0x3b64b61f,0xbb64b61f,0x361f3b64
    .long 0x323ebbd9,0xb8723aa7,0x3aa7b872,0xbbd9323e,0xbbd9b23e,0x3aa73872,0xb872baa7,0x323e3bd9
    .long 0x3c000000,0xbc008000,0x3c000000,0xbc008000,0xbc00,0x80003c00,0xbc00,0x80003c00
    .long 0x3bd9b23e,0xbaa73872,0x3872baa7,0xb23e3bd9,0xb23ebbd9,0x38723aa7,0xbaa7b872,0x3bd9323e
    .long 0x3b64b61f,0xb61f3b64,0xb61fbb64,0x3b64361f,0xb61fbb64,0x3b64361f,0xbb64361f,0x361fbb64
    .long 0x3aa7b872,0x323e3bd9,0xbbd9b23e,0x3872baa7,0xb872baa7,0x3bd9b23e,0xb23e3bd9,0xbaa7b872
    .long 0x39a8b9a8,0x39a839a8,0xb9a839a8,0xb9a8b9a8,0xb9a8b9a8,0x39a8b9a8,0x39a839a8,0xb9a839a8
    .long 0x3872baa7,0x3bd9323e,0x323e3bd9,0xbaa73872,0xbaa7b872,0x323ebbd9,0x3bd9b23e,0x38723aa7
    .long 0x361fbb64,0x3b64b61f,0x3b64361f,0x361f3b64,0xbb64b61f,0xb61fbb64,0x361fbb64,0x3b64b61f
    .long 0x323ebbd9,0x3872baa7,0x3aa7b872,0x3bd9b23e,0xbbd9b23e,0xbaa7b872,0xb872baa7,0xb23ebbd9
    .long 0x3c000000,0xbc008000,0x3c000000,0xbc008000,0xbc00,0x80003c00,0xbc00,0x80003c00
    .long 0xb23ebbd9,0x38723aa7,0xbaa7b872,0x3bd9323e,0xbbd9323e,0x3aa7b872,0xb8723aa7,0x323ebbd9
    .long 0xbb64361f,0x361fbb64,0x361f3b64,0xbb64b61f,0x361f3b64,0xbb64b61f,0x3b64b61f,0xb61f3b64
    .long 0x38723aa7,0xbbd9323e,0x323ebbd9,0x3aa73872,0x3aa7b872,0x323e3bd9,0xbbd9b23e,0x3872baa7
    .long 0x39a8b9a8,0x39a839a8,0xb9a839a8,0xb9a8b9a8,0xb9a8b9a8,0x39a8b9a8,0x39a839a8,0xb9a839a8
    .long 0xbaa7b872,0x323ebbd9,0x3bd9b23e,0x38723aa7,0xb8723aa7,0xbbd9b23e,0xb23ebbd9,0x3aa7b872
    .long 0xb61f3b64,0xbb64361f,0xbb64b61f,0xb61fbb64,0x3b64361f,0x361f3b64,0xb61f3b64,0xbb64361f
    .long 0x3bd9323e,0x3aa73872,0x38723aa7,0x323e3bd9,0x323ebbd9,0x3872baa7,0x3aa7b872,0x3bd9b23e
    .long 0x3c000000,0xbc008000,0x3c000000,0xbc008000,0xbc00,0x80003c00,0xbc00,0x80003c00
    .long 0xbbd9323e,0x3aa7b872,0xb8723aa7,0x323ebbd9,0x323e3bd9,0xb872baa7,0x3aa73872,0xbbd9b23e
    .long 0x3b64b61f,0xb61f3b64,0xb61fbb64,0x3b64361f,0xb61fbb64,0x3b64361f,0xbb64361f,0x361fbb64
    .long 0xbaa73872,0xb23ebbd9,0x3bd9323e,0xb8723aa7,0x38723aa7,0xbbd9323e,0x323ebbd9,0x3aa73872
    .long 0x39a8b9a8,0x39a839a8,0xb9a839a8,0xb9a8b9a8,0xb9a8b9a8,0x39a8b9a8,0x39a839a8,0xb9a839a8
    .long 0xb8723aa7,0xbbd9b23e,0xb23ebbd9,0x3aa7b872,0x3aa73872,0xb23e3bd9,0xbbd9323e,0xb872baa7
    .long 0x361fbb64,0x3b64b61f,0x3b64361f,0x361f3b64,0xbb64b61f,0xb61fbb64,0x361fbb64,0x3b64b61f
    .long 0xb23e3bd9,0xb8723aa7,0xbaa73872,0xbbd9323e,0x3bd9323e,0x3aa73872,0x38723aa7,0x323e3bd9
    .long 0x3c000000,0xbc008000,0x3c000000,0xbc008000,0xbc00,0x80003c00,0xbc00,0x80003c00
    .long 0x323e3bd9,0xb872baa7,0x3aa73872,0xbbd9b23e,0x3bd9b23e,0xbaa73872,0x3872baa7,0xb23e3bd9
    .long 0xbb64361f,0x361fbb64,0x361f3b64,0xbb64b61f,0x361f3b64,0xbb64b61f,0x3b64b61f,0xb61f3b64
    .long 0xb872baa7,0x3bd9b23e,0xb23e3bd9,0xbaa7b872,0xbaa73872,0xb23ebbd9,0x3bd9323e,0xb8723aa7
    .long 0x39a8b9a8,0x39a839a8,0xb9a839a8,0xb9a8b9a8,0xb9a8b9a8,0x39a8b9a8,0x39a839a8,0xb9a839a8
    .long 0x3aa73872,0xb23e3bd9,0xbbd9323e,0xb872baa7,0x3872baa7,0x3bd9323e,0x323e3bd9,0xbaa73872
    .long 0xb61f3b64,0xbb64361f,0xbb64b61f,0xb61fbb64,0x3b64361f,0x361f3b64,0xb61f3b64,0xbb64361f
    .long 0xbbd9b23e,0xbaa7b872,0xb872baa7,0xb23ebbd9,0xb23e3bd9,0xb8723aa7,0xbaa73872,0xbbd9323e
fft_tables_end:
.section .rodata,"a"
.p2align 6
.amdhsa_kernel recurrent_scan__spectral_gfnet__moe_arch_mod__prompt_kernel
  .amdhsa_next_free_vgpr 128
  .amdhsa_next_free_sgpr 102
  .amdhsa_accum_offset 128
  .amdhsa_group_segment_fixed_size 0
  .amdhsa_kernarg_size 88
  .amdhsa_user_sgpr_count 2
  .amdhsa_user_sgpr_kernarg_segment_ptr 1
  .amdhsa_system_sgpr_workgroup_id_x 1
  .amdhsa_float_denorm_mode_32 3
  .amdhsa_float_denorm_mode_16_64 3
.end_amdhsa_kernel
```
